```python
import torch

def _softmax(x, axis=-1):
    return torch.softmax(x, dim=axis)
def _gelu(x):
    return torch.nn.functional.gelu(x, approximate="tanh")
def _silu(x):
    return torch.nn.functional.silu(x)
def _sigmoid(x):
    return torch.sigmoid(x)
def _layernorm(x, axis=-1, eps=1e-5):
    m = x.mean(dim=axis, keepdim=True)
    v = x.var(dim=axis, keepdim=True, unbiased=False)
    return (x - m) / torch.sqrt(v + eps)
def _scatter_add(tgt, idx, src, axis=0):
    return tgt.clone().index_add_(axis, idx, src)
def _segment_sum(src, seg, n):
    out = torch.zeros((n,) + src.shape[1:], dtype=src.dtype)
    return out.index_add_(0, seg, src)
def _pad(x, pw):
    flat = tuple(v for pair in reversed(pw) for v in pair)
    return torch.nn.functional.pad(x, flat)

kernel_name = 'parallel_sum__grouped_kv_mqa__dense_activation_squared_relu__prompt'

def setup_inputs():

    _w = (lambda a: (lambda t: t.to(torch.bfloat16) if t.is_floating_point() else t)(torch.as_tensor(a)))
    def _A_setup():
        B, S, D, H = 1, 2048, 576, 32
        Dh = D // H
        return {
            "x": _w((lambda *s: torch.randn(*s, dtype=torch.bfloat16) * 0.05)(B, S, D)),
            "wq": _w((lambda *s: torch.randn(*s, dtype=torch.bfloat16) * 0.2)(D, H * Dh)),
            "wk": _w((lambda *s: torch.randn(*s, dtype=torch.bfloat16) * 0.2)(D, Dh)),
            "wv": _w((lambda *s: torch.randn(*s, dtype=torch.bfloat16) * 0.1)(D, Dh)),
            "wo": _w((lambda *s: torch.randn(*s, dtype=torch.bfloat16) * 0.1)(H * Dh, D)),
        }
    _A_in = _A_setup()

    def _B_setup():
        B, S, D, F = 1, 2048, 576, 4608
        return {
            "x": _w((lambda *s: torch.randn(*s, dtype=torch.bfloat16) * 0.05)(B, S, D)),
            "w1": _w((lambda *s: torch.randn(*s, dtype=torch.bfloat16) * 0.05)(D, F)),
            "b1": _w((lambda *s: torch.randn(*s, dtype=torch.bfloat16) * 0.8)(F)),
            "w2": _w((lambda *s: torch.randn(*s, dtype=torch.bfloat16) * 0.05)(F, D)),
            "b2": _w((lambda *s: torch.randn(*s, dtype=torch.bfloat16) * 12.8)(D)),
        }
    _B_in = _B_setup()

    return {
        "A_x": _A_in["x"],
        "A_wq": _A_in["wq"],
        "A_wk": _A_in["wk"],
        "A_wv": _A_in["wv"],
        "A_wo": _A_in["wo"],
        "B_x": _B_in["x"],
        "B_w1": _B_in["w1"],
        "B_b1": _B_in["b1"],
        "B_w2": _B_in["w2"],
        "B_b2": _B_in["b2"],
    }

def reference(A_x, A_wq, A_wk, A_wv, A_wo, B_x, B_w1, B_b1, B_w2, B_b2):
    def _A_ref(x, wq, wk, wv, wo):
        B, S, D = x.shape
        H = 32
        Dh = D // H
        q = (lambda x, *d: x.permute(*d))((x @ wq).reshape(B, S, H, Dh), 0, 2, 1, 3)
        k = x @ wk
        v = x @ wv
        scores = torch.einsum("bhqd,bkd->bhqk", q, k) * (Dh ** -0.5)
        p = _softmax(scores, axis=-1)
        o = torch.einsum("bhqk,bkd->bhqd", p, v)
        return (lambda x, *d: x.permute(*d))(o, 0, 2, 1, 3).reshape(B, S, H * Dh) @ wo

    def _B_ref(x, w1, b1, w2, b2):
        h = torch.einsum("bsd,df->bsf", x, w1) + b1
        zero = torch.zeros_like(h)
        r = torch.where(h > zero, h, zero)
        h = r * r
        out = torch.einsum("bsf,fd->bsd", h, w2) + b2
        return out

    x = A_x
    xn = _layernorm(x, axis=-1)
    return x + _A_ref(xn, A_wq, A_wk, A_wv, A_wo) + _B_ref(xn, B_w1, B_b1, B_w2, B_b2)
```

```asm
; @launch grid=(256,1,1) block=(512,1,1) lds=159808
.amdgcn_target "amdgcn-amd-amdhsa--gfx950"
.text
.globl parallel_sum__grouped_kv_mqa__dense_activation_squared_relu__prompt_kernel
.p2align 8
.type parallel_sum__grouped_kv_mqa__dense_activation_squared_relu__prompt_kernel,@function
parallel_sum__grouped_kv_mqa__dense_activation_squared_relu__prompt_kernel:
    s_cmp_ge_u32 s2, 256
    s_cbranch_scc1 ka_end
    s_load_dwordx4 s[24:27], s[0:1], 0
    s_load_dwordx4 s[28:31], s[0:1], 16
    s_load_dwordx4 s[32:35], s[0:1], 48
    s_load_dwordx2 s[60:61], s[0:1], 64
    s_load_dwordx4 s[64:67], s[0:1], 88
    v_lshrrev_b32 v2, 6, v0
    s_nop 0
    v_readfirstlane_b32 s39, v2
    s_and_b32 s41, s2, 3
    s_lshl_b32 s41, s41, 2
    s_bfe_u32 s42, s2, 0x20003
    s_add_u32 s41, s41, s42
    s_bfe_u32 s42, s2, 0x10002
    s_lshl_b32 s42, s42, 3
    s_lshr_b32 s43, s2, 5
    s_add_u32 s42, s42, s43
    s_waitcnt lgkmcnt(0)
    s_mov_b32 s4, s24
    s_mov_b32 s5, s25
    s_mov_b32 s6, 2359296
    s_mov_b32 s7, 0x00020000
    s_mov_b32 s12, s66
    s_mov_b32 s13, s67
    s_mov_b32 s14, 268435456
    s_mov_b32 s15, 0x00020000
    s_mov_b32 s16, s34
    s_mov_b32 s17, s35
    s_mov_b32 s18, 9216
    s_mov_b32 s19, 0x00020000
    s_mov_b32 s20, s64
    s_mov_b32 s21, s65
    s_mov_b32 s22, 256
    s_mov_b32 s23, 0x00020000
    s_mov_b32 s34, s60
    s_mov_b32 s35, s61
    s_cmp_lt_u32 s39, 4
    s_cbranch_scc1 ka_a
    v_mov_b32 v15, 159744
    v_mov_b32 v16, 0
    v_mov_b32 v17, 0
    v_mov_b32 v18, 0
    v_mov_b32 v19, 0
    ds_write_b128 v15, v[16:19]
    ds_write_b128 v15, v[16:19] offset:16
    v_mov_b32 v15, 159748
    v_and_b32 v1, 63, v0
    v_lshrrev_b32 v28, 6, v0
    s_nop 0
    v_readfirstlane_b32 s40, v28
    v_lshrrev_b32 v28, 5, v1
    v_bfe_u32 v29, v1, 2, 2
    v_lshl_add_u32 v28, v28, 2, v29
    v_lshlrev_b32 v28, 7, v28
    v_bfe_u32 v30, v1, 4, 1
    v_bfe_u32 v31, v1, 1, 1
    v_lshl_add_u32 v30, v30, 1, v31
    v_lshrrev_b32 v29, 1, v29
    v_lshlrev_b32 v29, 2, v29
    v_xor_b32 v30, v30, v29
    v_lshl_add_u32 v28, v30, 4, v28
    v_and_b32 v31, 1, v1
    v_lshl_add_u32 v5, v31, 3, v28
    v_add_u32 v6, 0x9000, v5
    v_xor_b32 v7, 64, v5
    v_xor_b32 v8, 64, v6
    v_lshlrev_b32 v9, 4, v1
    s_mul_i32 s57, s40, 6144
    s_and_b32 s40, s40, 3
    s_mul_i32 s57, s40, 6144
    s_mov_b32 s66, 0
    v_mov_b32 v14, 1
    s_lshl_b32 s43, s42, 2
    s_add_u32 s43, s43, s40
    s_add_u32 s60, s41, s42
    s_mul_i32 s61, s60, 86
    s_lshr_b32 s61, s61, 8
    s_mul_i32 s61, s61, 3
    s_sub_u32 s92, s60, s61
    s_add_u32 s93, s92, 1
    s_cmp_eq_u32 s93, 3
    s_cselect_b32 s93, 0, s93
    s_add_u32 s94, s93, 1
    s_cmp_eq_u32 s94, 3
    s_cselect_b32 s94, 0, s94
    v_lshrrev_b32 v28, 3, v1
    v_and_b32 v29, 7, v1
    v_lshrrev_b32 v30, 4, v1
    v_xor_b32 v29, v29, v30
    v_mul_u32_u24 v28, 1152, v28
    v_lshl_add_u32 v44, v29, 4, v28
    v_xor_b32 v45, 64, v44
    s_mul_i32 s65, s43, 36864
    s_mul_i32 s64, s92, 384
    s_add_u32 s64, s64, s65
    s_add_u32 m0, s57, 73728
    s_add_u32 s61, s64, 0
    buffer_load_dwordx4 v44, s[4:7], s61 offen lds
    s_add_u32 m0, s57, 74752
    s_add_u32 s61, s64, 9216
    buffer_load_dwordx4 v45, s[4:7], s61 offen lds
    s_add_u32 m0, s57, 75776
    s_add_u32 s61, s64, 18432
    buffer_load_dwordx4 v44, s[4:7], s61 offen lds
    s_add_u32 m0, s57, 76800
    s_add_u32 s61, s64, 27648
    buffer_load_dwordx4 v45, s[4:7], s61 offen lds
    s_add_u32 m0, s57, 98304
    s_add_u32 s61, s64, 128
    buffer_load_dwordx4 v44, s[4:7], s61 offen lds
    s_add_u32 m0, s57, 99328
    s_add_u32 s61, s64, 9344
    buffer_load_dwordx4 v45, s[4:7], s61 offen lds
    s_add_u32 m0, s57, 100352
    s_add_u32 s61, s64, 18560
    buffer_load_dwordx4 v44, s[4:7], s61 offen lds
    s_add_u32 m0, s57, 101376
    s_add_u32 s61, s64, 27776
    buffer_load_dwordx4 v45, s[4:7], s61 offen lds
    s_add_u32 m0, s57, 122880
    s_add_u32 s61, s64, 256
    buffer_load_dwordx4 v44, s[4:7], s61 offen lds
    s_add_u32 m0, s57, 123904
    s_add_u32 s61, s64, 9472
    buffer_load_dwordx4 v45, s[4:7], s61 offen lds
    s_add_u32 m0, s57, 124928
    s_add_u32 s61, s64, 18688
    buffer_load_dwordx4 v44, s[4:7], s61 offen lds
    s_add_u32 m0, s57, 125952
    s_add_u32 s61, s64, 27904
    buffer_load_dwordx4 v45, s[4:7], s61 offen lds
    s_waitcnt lgkmcnt(0)
    s_barrier
    s_mul_i32 s64, s93, 384
    s_add_u32 s64, s64, s65
    s_add_u32 m0, s57, 77824
    s_add_u32 s61, s64, 0
    buffer_load_dwordx4 v44, s[4:7], s61 offen lds
    s_add_u32 m0, s57, 78848
    s_add_u32 s61, s64, 9216
    buffer_load_dwordx4 v45, s[4:7], s61 offen lds
    s_add_u32 m0, s57, 102400
    s_add_u32 s61, s64, 18432
    buffer_load_dwordx4 v44, s[4:7], s61 offen lds
    s_add_u32 m0, s57, 103424
    s_add_u32 s61, s64, 27648
    buffer_load_dwordx4 v45, s[4:7], s61 offen lds
    s_lshr_b32 s38, s41, 2
    s_and_b32 s59, s41, 3
    s_mul_i32 s48, s38, 18
    s_and_b32 s55, s59, 1
    s_cmp_eq_u32 s41, 2
    s_cselect_b32 s55, 1, s55
    s_cmp_eq_u32 s41, 6
    s_cselect_b32 s55, 2, s55
    s_lshl_b32 s36, s48, 7
    s_mov_b32 s48, 12879904
    s_cmp_eq_u32 s59, 1
    s_cselect_b32 s48, 332931, s48
    s_cmp_eq_u32 s59, 2
    s_cselect_b32 s48, 15123983, s48
    s_cmp_eq_u32 s59, 3
    s_cselect_b32 s48, 368870, s48
    s_mov_b32 s37, s48
    s_and_b32 s61, s48, 31
    s_mul_i32 s62, s38, 18
    s_add_u32 s62, s62, s61
    s_cmp_eq_u32 s55, 0
    s_cselect_b32 s60, 5, 0
    s_lshr_b32 s48, s48, s60
    s_mov_b32 s67, 5
    s_cmp_eq_u32 s41, 2
    s_cselect_b32 s67, 6, s67
    s_cmp_eq_u32 s41, 6
    s_cselect_b32 s67, 6, s67
    s_lshr_b32 s60, s41, 1
    s_cmp_eq_u32 s41, 2
    s_cselect_b32 s60, 8, s60
    s_cmp_eq_u32 s55, 1
    s_cselect_b32 s63, s60, s62
    s_cselect_b32 s8, s26, s32
    s_cselect_b32 s9, s27, s33
    s_mov_b32 s10, 5308416
    s_cselect_b32 s10, 663552, s10
    s_mov_b32 s11, 0x00020000
    s_mov_b32 s49, 9216
    s_cselect_b32 s49, 1152, s49
    s_cselect_b32 s61, 0, 36
    s_lshl_b32 s60, s63, 2
    s_add_u32 s60, s60, s61
    s_mul_i32 s68, s43, 324
    s_add_u32 s60, s60, s68
    s_lshl_b32 s50, s60, 10
    v_lshrrev_b32 v28, 3, v1
    v_and_b32 v29, 7, v1
    v_bfe_u32 v30, v1, 4, 1
    v_lshlrev_b32 v30, 2, v30
    v_xor_b32 v29, v29, v30
    v_mul_lo_u32 v28, v28, s49
    v_lshl_add_u32 v2, v29, 4, v28
    s_lshl_b32 s60, s49, 3
    s_sub_u32 s60, s60, 1024
    v_add_u32 v3, s60, v2
    v_add_u32 v4, s60, v3
    s_mul_i32 s53, s49, 192
    s_mul_i32 s54, s49, 24
    s_mul_i32 s95, s92, s53
    s_mul_i32 s96, s93, s53
    s_mul_i32 s97, s94, s53
    s_mul_i32 s60, s40, 48
    s_mul_i32 s60, s60, s49
    s_lshl_b32 s61, s63, 7
    s_add_u32 s45, s60, s61
    s_mov_b32 s47, s57
    s_mov_b32 s46, 0
    v_and_b32 v12, 31, v1
    v_lshlrev_b32 v12, 1, v12
    s_and_b32 s60, s48, 31
    s_lshl_b32 s60, s60, 7
    s_add_u32 s51, s60, s36
    s_lshr_b32 s48, s48, 5
    s_lshl_b32 s60, s63, 7
    s_cmp_eq_u32 s55, 0
    s_cselect_b32 s66, s60, 2147418112
    s_mov_b32 s90, s66
    s_mov_b32 s66, 0
    v_mov_b32 v37, 0
    v_mov_b32 v39, 0
    v_mov_b32 v33, 0
    v_and_b32 v28, 31, v1
    v_lshrrev_b32 v29, 1, v28
    v_and_b32 v29, 7, v29
    v_lshrrev_b32 v30, 5, v1
    v_xor_b32 v29, v29, v30
    v_lshlrev_b32 v29, 4, v29
    v_and_b32 v30, 7, v28
    v_lshl_add_u32 v29, v30, 7, v29
    v_add_u32 v29, s57, v29
    v_add_u32 v29, 73728, v29
    v_lshrrev_b32 v30, 3, v28
    v_lshl_add_u32 v16, v30, 10, v29
    v_and_b32 v31, 1, v30
    v_lshl_add_u32 v20, v31, 10, v29
    v_lshrrev_b32 v30, 1, v30
    v_mul_u32_u24 v30, 24576, v30
    v_add_u32 v20, v20, v30
    v_add_u32 v20, 4096, v20
    v_xor_b32 v17, 32, v16
    v_xor_b32 v21, 32, v20
    v_xor_b32 v18, 64, v16
    v_xor_b32 v22, 64, v20
    v_xor_b32 v19, 96, v16
    v_xor_b32 v23, 96, v20
    v_mov_b32 v24, 0
    v_mov_b32 v100, 0x3f803f80
    v_mov_b32 v25, 0
    v_mov_b32 v101, 0x3f803f80
    v_mov_b32 v26, 0
    v_mov_b32 v102, 0x3f803f80
    v_mov_b32 v27, 0
    v_mov_b32 v103, 0x3f803f80
    v_mov_b32 v46, 0x00003f80
    v_mov_b32 v47, 0x3f800000
    v_lshrrev_b32 v29, 5, v1
    v_lshlrev_b32 v29, 3, v29
    v_sub_u32 v28, v28, v29
    v_cmp_eq_u32 vcc, 0, v28
    v_cmp_eq_u32 s[98:99], 1, v28
    s_nop 1
    v_cndmask_b32 v104, 0, v46, vcc
    v_cndmask_b32 v104, v104, v47, s[98:99]
    v_cmp_eq_u32 vcc, 2, v28
    v_cmp_eq_u32 s[98:99], 3, v28
    s_nop 1
    v_cndmask_b32 v105, 0, v46, vcc
    v_cndmask_b32 v105, v105, v47, s[98:99]
    v_cmp_eq_u32 vcc, 4, v28
    v_cmp_eq_u32 s[98:99], 5, v28
    s_nop 1
    v_cndmask_b32 v106, 0, v46, vcc
    v_cndmask_b32 v106, v106, v47, s[98:99]
    v_cmp_eq_u32 vcc, 6, v28
    v_cmp_eq_u32 s[98:99], 7, v28
    s_nop 1
    v_cndmask_b32 v107, 0, v46, vcc
    v_cndmask_b32 v107, v107, v47, s[98:99]
    v_cmp_eq_u32 vcc, 16, v28
    v_cmp_eq_u32 s[98:99], 17, v28
    s_nop 1
    v_cndmask_b32 v108, 0, v46, vcc
    v_cndmask_b32 v108, v108, v47, s[98:99]
    v_cmp_eq_u32 vcc, 18, v28
    v_cmp_eq_u32 s[98:99], 19, v28
    s_nop 1
    v_cndmask_b32 v109, 0, v46, vcc
    v_cndmask_b32 v109, v109, v47, s[98:99]
    v_cmp_eq_u32 vcc, 20, v28
    v_cmp_eq_u32 s[98:99], 21, v28
    s_nop 1
    v_cndmask_b32 v110, 0, v46, vcc
    v_cndmask_b32 v110, v110, v47, s[98:99]
    v_cmp_eq_u32 vcc, 22, v28
    v_cmp_eq_u32 s[98:99], 23, v28
    s_nop 1
    v_cndmask_b32 v111, 0, v46, vcc
    v_cndmask_b32 v111, v111, v47, s[98:99]
    v_mov_b32 v31, s37
    v_add_u32 v28, 0, v1
    v_min_u32 v28, 89, v28
    v_mul_u32_u24 v29, 205, v28
    v_lshrrev_b32 v29, 10, v29
    v_mul_u32_u24 v30, 5, v29
    v_sub_u32 v30, v28, v30
    v_mul_u32_u24 v29, 9216, v29
    v_mul_u32_u24 v30, 5, v30
    v_lshrrev_b32 v30, v30, v31
    v_and_b32 v30, 31, v30
    v_lshl_add_u32 v96, v30, 7, v29
    v_add_u32 v28, 64, v1
    v_min_u32 v28, 89, v28
    v_mul_u32_u24 v29, 205, v28
    v_lshrrev_b32 v29, 10, v29
    v_mul_u32_u24 v30, 5, v29
    v_sub_u32 v30, v28, v30
    v_mul_u32_u24 v29, 9216, v29
    v_mul_u32_u24 v30, 5, v30
    v_lshrrev_b32 v30, v30, v31
    v_and_b32 v30, 31, v30
    v_lshl_add_u32 v97, v30, 7, v29
    s_lshr_b32 s91, s2, 5
    s_lshl_b32 s91, s91, 2
    s_add_u32 s91, s91, s40
    s_mul_i32 s91, s91, 165888
    s_add_u32 s91, s91, s36
    s_mov_b32 s100, s90
    s_mov_b32 s101, s91
    s_waitcnt vmcnt(12)
    ds_read_b128 v[112:115], v16 offset:0
    ds_read_b128 v[116:119], v17 offset:0
    ds_read_b128 v[120:123], v18 offset:0
    ds_read_b128 v[124:127], v19 offset:0
    s_waitcnt lgkmcnt(0)
    s_add_u32 m0, s57, 73728
    s_add_u32 s61, s64, 128
    buffer_load_dwordx4 v44, s[4:7], s61 offen lds
    s_add_u32 m0, s57, 74752
    s_add_u32 s61, s64, 9344
    buffer_load_dwordx4 v45, s[4:7], s61 offen lds
    s_add_u32 m0, s57, 75776
    s_add_u32 s61, s64, 18560
    buffer_load_dwordx4 v44, s[4:7], s61 offen lds
    s_add_u32 m0, s57, 76800
    s_add_u32 s61, s64, 27776
    buffer_load_dwordx4 v45, s[4:7], s61 offen lds
    s_waitcnt vmcnt(12)
    ds_read_b128 v[128:131], v16 offset:24576
    ds_read_b128 v[132:135], v17 offset:24576
    ds_read_b128 v[136:139], v18 offset:24576
    ds_read_b128 v[140:143], v19 offset:24576
    v_mfma_f32_32x32x16_bf16 v[48:63], v[100:103], v[112:115], 0
    v_dot2c_f32_bf16 v24, v112, v112
    v_dot2c_f32_bf16 v25, v113, v113
    v_dot2c_f32_bf16 v26, v114, v114
    v_dot2c_f32_bf16 v27, v115, v115
    v_mfma_f32_32x32x16_bf16 v[48:63], v[100:103], v[116:119], v[48:63]
    v_dot2c_f32_bf16 v24, v116, v116
    v_dot2c_f32_bf16 v25, v117, v117
    v_dot2c_f32_bf16 v26, v118, v118
    v_dot2c_f32_bf16 v27, v119, v119
    v_mfma_f32_32x32x16_bf16 v[48:63], v[100:103], v[120:123], v[48:63]
    v_dot2c_f32_bf16 v24, v120, v120
    v_dot2c_f32_bf16 v25, v121, v121
    v_dot2c_f32_bf16 v26, v122, v122
    v_dot2c_f32_bf16 v27, v123, v123
    v_mfma_f32_32x32x16_bf16 v[48:63], v[100:103], v[124:127], v[48:63]
    v_dot2c_f32_bf16 v24, v124, v124
    v_dot2c_f32_bf16 v25, v125, v125
    v_dot2c_f32_bf16 v26, v126, v126
    v_dot2c_f32_bf16 v27, v127, v127
    s_waitcnt lgkmcnt(0)
    s_add_u32 m0, s57, 98304
    s_add_u32 s61, s64, 256
    buffer_load_dwordx4 v44, s[4:7], s61 offen lds
    s_add_u32 m0, s57, 99328
    s_add_u32 s61, s64, 9472
    buffer_load_dwordx4 v45, s[4:7], s61 offen lds
    s_add_u32 m0, s57, 100352
    s_add_u32 s61, s64, 18688
    buffer_load_dwordx4 v44, s[4:7], s61 offen lds
    s_add_u32 m0, s57, 101376
    s_add_u32 s61, s64, 27904
    buffer_load_dwordx4 v45, s[4:7], s61 offen lds
    s_waitcnt vmcnt(12)
    ds_read_b128 v[144:147], v16 offset:49152
    ds_read_b128 v[148:151], v17 offset:49152
    ds_read_b128 v[152:155], v18 offset:49152
    ds_read_b128 v[156:159], v19 offset:49152
    v_mfma_f32_32x32x16_bf16 v[48:63], v[100:103], v[128:131], v[48:63]
    v_dot2c_f32_bf16 v24, v128, v128
    v_dot2c_f32_bf16 v25, v129, v129
    v_dot2c_f32_bf16 v26, v130, v130
    v_dot2c_f32_bf16 v27, v131, v131
    v_mfma_f32_32x32x16_bf16 v[48:63], v[100:103], v[132:135], v[48:63]
    v_dot2c_f32_bf16 v24, v132, v132
    v_dot2c_f32_bf16 v25, v133, v133
    v_dot2c_f32_bf16 v26, v134, v134
    v_dot2c_f32_bf16 v27, v135, v135
    v_mfma_f32_32x32x16_bf16 v[48:63], v[100:103], v[136:139], v[48:63]
    v_dot2c_f32_bf16 v24, v136, v136
    v_dot2c_f32_bf16 v25, v137, v137
    v_dot2c_f32_bf16 v26, v138, v138
    v_dot2c_f32_bf16 v27, v139, v139
    v_mfma_f32_32x32x16_bf16 v[48:63], v[100:103], v[140:143], v[48:63]
    v_dot2c_f32_bf16 v24, v140, v140
    v_dot2c_f32_bf16 v25, v141, v141
    v_dot2c_f32_bf16 v26, v142, v142
    v_dot2c_f32_bf16 v27, v143, v143
    s_waitcnt lgkmcnt(0)
    s_mul_i32 s64, s94, 384
    s_add_u32 s64, s64, s65
    s_add_u32 m0, s57, 122880
    s_add_u32 s61, s64, 0
    buffer_load_dwordx4 v44, s[4:7], s61 offen lds
    s_add_u32 m0, s57, 123904
    s_add_u32 s61, s64, 9216
    buffer_load_dwordx4 v45, s[4:7], s61 offen lds
    s_add_u32 m0, s57, 124928
    s_add_u32 s61, s64, 18432
    buffer_load_dwordx4 v44, s[4:7], s61 offen lds
    s_add_u32 m0, s57, 125952
    s_add_u32 s61, s64, 27648
    buffer_load_dwordx4 v45, s[4:7], s61 offen lds
    s_waitcnt vmcnt(12)
    ds_read_b128 v[160:163], v20 offset:0
    ds_read_b128 v[164:167], v21 offset:0
    ds_read_b128 v[168:171], v22 offset:0
    ds_read_b128 v[172:175], v23 offset:0
    v_mfma_f32_32x32x16_bf16 v[48:63], v[100:103], v[144:147], v[48:63]
    v_dot2c_f32_bf16 v24, v144, v144
    v_dot2c_f32_bf16 v25, v145, v145
    v_dot2c_f32_bf16 v26, v146, v146
    v_dot2c_f32_bf16 v27, v147, v147
    v_mfma_f32_32x32x16_bf16 v[48:63], v[100:103], v[148:151], v[48:63]
    v_dot2c_f32_bf16 v24, v148, v148
    v_dot2c_f32_bf16 v25, v149, v149
    v_dot2c_f32_bf16 v26, v150, v150
    v_dot2c_f32_bf16 v27, v151, v151
    v_mfma_f32_32x32x16_bf16 v[48:63], v[100:103], v[152:155], v[48:63]
    v_dot2c_f32_bf16 v24, v152, v152
    v_dot2c_f32_bf16 v25, v153, v153
    v_dot2c_f32_bf16 v26, v154, v154
    v_dot2c_f32_bf16 v27, v155, v155
    v_mfma_f32_32x32x16_bf16 v[48:63], v[100:103], v[156:159], v[48:63]
    v_dot2c_f32_bf16 v24, v156, v156
    v_dot2c_f32_bf16 v25, v157, v157
    v_dot2c_f32_bf16 v26, v158, v158
    v_dot2c_f32_bf16 v27, v159, v159
    s_waitcnt lgkmcnt(0)
    s_add_u32 m0, s57, 77824
    s_add_u32 s61, s64, 128
    buffer_load_dwordx4 v44, s[4:7], s61 offen lds
    s_add_u32 m0, s57, 78848
    s_add_u32 s61, s64, 9344
    buffer_load_dwordx4 v45, s[4:7], s61 offen lds
    s_add_u32 m0, s57, 102400
    s_add_u32 s61, s64, 18560
    buffer_load_dwordx4 v44, s[4:7], s61 offen lds
    s_add_u32 m0, s57, 103424
    s_add_u32 s61, s64, 27776
    buffer_load_dwordx4 v45, s[4:7], s61 offen lds
    s_waitcnt vmcnt(12)
    ds_read_b128 v[176:179], v16 offset:0
    ds_read_b128 v[180:183], v17 offset:0
    ds_read_b128 v[184:187], v18 offset:0
    ds_read_b128 v[188:191], v19 offset:0
    v_mfma_f32_32x32x16_bf16 v[48:63], v[100:103], v[160:163], v[48:63]
    v_dot2c_f32_bf16 v24, v160, v160
    v_dot2c_f32_bf16 v25, v161, v161
    v_dot2c_f32_bf16 v26, v162, v162
    v_dot2c_f32_bf16 v27, v163, v163
    v_mfma_f32_32x32x16_bf16 v[48:63], v[100:103], v[164:167], v[48:63]
    v_dot2c_f32_bf16 v24, v164, v164
    v_dot2c_f32_bf16 v25, v165, v165
    v_dot2c_f32_bf16 v26, v166, v166
    v_dot2c_f32_bf16 v27, v167, v167
    v_mfma_f32_32x32x16_bf16 v[48:63], v[100:103], v[168:171], v[48:63]
    v_dot2c_f32_bf16 v24, v168, v168
    v_dot2c_f32_bf16 v25, v169, v169
    v_dot2c_f32_bf16 v26, v170, v170
    v_dot2c_f32_bf16 v27, v171, v171
    v_mfma_f32_32x32x16_bf16 v[48:63], v[100:103], v[172:175], v[48:63]
    v_dot2c_f32_bf16 v24, v172, v172
    v_dot2c_f32_bf16 v25, v173, v173
    v_dot2c_f32_bf16 v26, v174, v174
    v_dot2c_f32_bf16 v27, v175, v175
    s_waitcnt lgkmcnt(0)
    s_add_u32 m0, s57, 73728
    s_add_u32 s61, s64, 256
    buffer_load_dwordx4 v44, s[4:7], s61 offen lds
    s_add_u32 m0, s57, 74752
    s_add_u32 s61, s64, 9472
    buffer_load_dwordx4 v45, s[4:7], s61 offen lds
    s_add_u32 m0, s57, 75776
    s_add_u32 s61, s64, 18688
    buffer_load_dwordx4 v44, s[4:7], s61 offen lds
    s_add_u32 m0, s57, 76800
    s_add_u32 s61, s64, 27904
    buffer_load_dwordx4 v45, s[4:7], s61 offen lds
    s_waitcnt vmcnt(12)
    ds_read_b128 v[192:195], v16 offset:24576
    ds_read_b128 v[196:199], v17 offset:24576
    ds_read_b128 v[200:203], v18 offset:24576
    ds_read_b128 v[204:207], v19 offset:24576
    v_mfma_f32_32x32x16_bf16 v[48:63], v[100:103], v[176:179], v[48:63]
    v_dot2c_f32_bf16 v24, v176, v176
    v_dot2c_f32_bf16 v25, v177, v177
    v_dot2c_f32_bf16 v26, v178, v178
    v_dot2c_f32_bf16 v27, v179, v179
    v_mfma_f32_32x32x16_bf16 v[48:63], v[100:103], v[180:183], v[48:63]
    v_dot2c_f32_bf16 v24, v180, v180
    v_dot2c_f32_bf16 v25, v181, v181
    v_dot2c_f32_bf16 v26, v182, v182
    v_dot2c_f32_bf16 v27, v183, v183
    v_mfma_f32_32x32x16_bf16 v[48:63], v[100:103], v[184:187], v[48:63]
    v_dot2c_f32_bf16 v24, v184, v184
    v_dot2c_f32_bf16 v25, v185, v185
    v_dot2c_f32_bf16 v26, v186, v186
    v_dot2c_f32_bf16 v27, v187, v187
    v_mfma_f32_32x32x16_bf16 v[48:63], v[100:103], v[188:191], v[48:63]
    v_dot2c_f32_bf16 v24, v188, v188
    v_dot2c_f32_bf16 v25, v189, v189
    v_dot2c_f32_bf16 v26, v190, v190
    v_dot2c_f32_bf16 v27, v191, v191
    s_waitcnt lgkmcnt(0)
    s_cmp_eq_u32 s55, 2
    s_cbranch_scc1 g_kvd0
    s_add_u32 m0, s47, 0
    s_add_u32 s61, s45, s95
    buffer_load_dwordx4 v2, s[8:11], s61 offen offset:0 lds
    buffer_load_dwordx4 v3, s[8:11], s61 offen offset:1024 lds
    buffer_load_dwordx4 v4, s[8:11], s61 offen offset:2048 lds
    s_add_u32 m0, s47, 3072
    s_add_u32 s61, s61, s54
    buffer_load_dwordx4 v2, s[8:11], s61 offen offset:0 lds
    buffer_load_dwordx4 v3, s[8:11], s61 offen offset:1024 lds
    buffer_load_dwordx4 v4, s[8:11], s61 offen offset:2048 lds
    s_add_u32 s47, s47, 24576
    s_cmp_ge_u32 s47, 98304
    s_cselect_b32 s61, 98304, 0
    s_sub_u32 s47, s47, s61
g_kvd0_ret:
    s_waitcnt vmcnt(14)
    ds_read_b128 v[208:211], v16 offset:49152
    ds_read_b128 v[212:215], v17 offset:49152
    ds_read_b128 v[216:219], v18 offset:49152
    ds_read_b128 v[220:223], v19 offset:49152
    v_mfma_f32_32x32x16_bf16 v[48:63], v[100:103], v[192:195], v[48:63]
    v_dot2c_f32_bf16 v24, v192, v192
    v_dot2c_f32_bf16 v25, v193, v193
    v_dot2c_f32_bf16 v26, v194, v194
    v_dot2c_f32_bf16 v27, v195, v195
    v_mfma_f32_32x32x16_bf16 v[48:63], v[100:103], v[196:199], v[48:63]
    v_dot2c_f32_bf16 v24, v196, v196
    v_dot2c_f32_bf16 v25, v197, v197
    v_dot2c_f32_bf16 v26, v198, v198
    v_dot2c_f32_bf16 v27, v199, v199
    v_mfma_f32_32x32x16_bf16 v[48:63], v[100:103], v[200:203], v[48:63]
    v_dot2c_f32_bf16 v24, v200, v200
    v_dot2c_f32_bf16 v25, v201, v201
    v_dot2c_f32_bf16 v26, v202, v202
    v_dot2c_f32_bf16 v27, v203, v203
    v_mfma_f32_32x32x16_bf16 v[48:63], v[100:103], v[204:207], v[48:63]
    v_dot2c_f32_bf16 v24, v204, v204
    v_dot2c_f32_bf16 v25, v205, v205
    v_dot2c_f32_bf16 v26, v206, v206
    v_dot2c_f32_bf16 v27, v207, v207
    s_waitcnt lgkmcnt(0)
    s_cmp_eq_u32 s55, 2
    s_cbranch_scc1 g_kvd1
    s_add_u32 m0, s47, 0
    s_add_u32 s61, s45, s96
    buffer_load_dwordx4 v2, s[8:11], s61 offen offset:0 lds
    buffer_load_dwordx4 v3, s[8:11], s61 offen offset:1024 lds
    buffer_load_dwordx4 v4, s[8:11], s61 offen offset:2048 lds
    s_add_u32 m0, s47, 3072
    s_add_u32 s61, s61, s54
    buffer_load_dwordx4 v2, s[8:11], s61 offen offset:0 lds
    buffer_load_dwordx4 v3, s[8:11], s61 offen offset:1024 lds
    buffer_load_dwordx4 v4, s[8:11], s61 offen offset:2048 lds
    s_add_u32 s47, s47, 24576
    s_cmp_ge_u32 s47, 98304
    s_cselect_b32 s61, 98304, 0
    s_sub_u32 s47, s47, s61
g_kvd1_ret:
    s_waitcnt vmcnt(16)
    ds_read_b128 v[224:227], v20 offset:0
    ds_read_b128 v[228:231], v21 offset:0
    ds_read_b128 v[232:235], v22 offset:0
    ds_read_b128 v[236:239], v23 offset:0
    v_mfma_f32_32x32x16_bf16 v[48:63], v[100:103], v[208:211], v[48:63]
    v_dot2c_f32_bf16 v24, v208, v208
    v_dot2c_f32_bf16 v25, v209, v209
    v_dot2c_f32_bf16 v26, v210, v210
    v_dot2c_f32_bf16 v27, v211, v211
    v_mfma_f32_32x32x16_bf16 v[48:63], v[100:103], v[212:215], v[48:63]
    v_dot2c_f32_bf16 v24, v212, v212
    v_dot2c_f32_bf16 v25, v213, v213
    v_dot2c_f32_bf16 v26, v214, v214
    v_dot2c_f32_bf16 v27, v215, v215
    v_mfma_f32_32x32x16_bf16 v[48:63], v[100:103], v[216:219], v[48:63]
    v_dot2c_f32_bf16 v24, v216, v216
    v_dot2c_f32_bf16 v25, v217, v217
    v_dot2c_f32_bf16 v26, v218, v218
    v_dot2c_f32_bf16 v27, v219, v219
    v_mfma_f32_32x32x16_bf16 v[48:63], v[100:103], v[220:223], v[48:63]
    v_dot2c_f32_bf16 v24, v220, v220
    v_dot2c_f32_bf16 v25, v221, v221
    v_dot2c_f32_bf16 v26, v222, v222
    v_dot2c_f32_bf16 v27, v223, v223
    s_waitcnt lgkmcnt(0)
    s_cmp_eq_u32 s55, 2
    s_cbranch_scc1 g_kvd2
    s_add_u32 m0, s47, 0
    s_add_u32 s61, s45, s97
    buffer_load_dwordx4 v2, s[8:11], s61 offen offset:0 lds
    buffer_load_dwordx4 v3, s[8:11], s61 offen offset:1024 lds
    buffer_load_dwordx4 v4, s[8:11], s61 offen offset:2048 lds
    s_add_u32 m0, s47, 3072
    s_add_u32 s61, s61, s54
    buffer_load_dwordx4 v2, s[8:11], s61 offen offset:0 lds
    buffer_load_dwordx4 v3, s[8:11], s61 offen offset:1024 lds
    buffer_load_dwordx4 v4, s[8:11], s61 offen offset:2048 lds
    s_add_u32 s47, s47, 24576
    s_cmp_ge_u32 s47, 98304
    s_cselect_b32 s61, 98304, 0
    s_sub_u32 s47, s47, s61
g_kvd2_ret:
    s_waitcnt vmcnt(18)
    ds_read_b128 v[240:243], v16 offset:0
    ds_read_b128 v[244:247], v17 offset:0
    ds_read_b128 v[248:251], v18 offset:0
    ds_read_b128 v[252:255], v19 offset:0
    v_mfma_f32_32x32x16_bf16 v[48:63], v[100:103], v[224:227], v[48:63]
    v_dot2c_f32_bf16 v24, v224, v224
    v_dot2c_f32_bf16 v25, v225, v225
    v_dot2c_f32_bf16 v26, v226, v226
    v_dot2c_f32_bf16 v27, v227, v227
    v_mfma_f32_32x32x16_bf16 v[48:63], v[100:103], v[228:231], v[48:63]
    v_dot2c_f32_bf16 v24, v228, v228
    v_dot2c_f32_bf16 v25, v229, v229
    v_dot2c_f32_bf16 v26, v230, v230
    v_dot2c_f32_bf16 v27, v231, v231
    v_mfma_f32_32x32x16_bf16 v[48:63], v[100:103], v[232:235], v[48:63]
    v_dot2c_f32_bf16 v24, v232, v232
    v_dot2c_f32_bf16 v25, v233, v233
    v_dot2c_f32_bf16 v26, v234, v234
    v_dot2c_f32_bf16 v27, v235, v235
    v_mfma_f32_32x32x16_bf16 v[48:63], v[100:103], v[236:239], v[48:63]
    v_dot2c_f32_bf16 v24, v236, v236
    v_dot2c_f32_bf16 v25, v237, v237
    v_dot2c_f32_bf16 v26, v238, v238
    v_dot2c_f32_bf16 v27, v239, v239
    s_waitcnt lgkmcnt(0)
    buffer_load_ushort v36, v12, s[16:19], s100 offen
    buffer_load_ushort v38, v12, s[16:19], s100 offen offset:64
    s_mov_b32 s8, s32
    s_mov_b32 s9, s33
    s_mov_b32 s10, 5308416
    s_mov_b32 s11, 0x00020000
    buffer_load_dword v0, v96, s[8:11], s101 offen
    buffer_load_dword v0, v97, s[8:11], s101 offen
    v_mfma_f32_32x32x16_bf16 v[48:63], v[100:103], v[240:243], v[48:63]
    v_dot2c_f32_bf16 v24, v240, v240
    v_dot2c_f32_bf16 v25, v241, v241
    v_dot2c_f32_bf16 v26, v242, v242
    v_dot2c_f32_bf16 v27, v243, v243
    v_mfma_f32_32x32x16_bf16 v[48:63], v[100:103], v[244:247], v[48:63]
    v_dot2c_f32_bf16 v24, v244, v244
    v_dot2c_f32_bf16 v25, v245, v245
    v_dot2c_f32_bf16 v26, v246, v246
    v_dot2c_f32_bf16 v27, v247, v247
    v_mfma_f32_32x32x16_bf16 v[48:63], v[100:103], v[248:251], v[48:63]
    v_dot2c_f32_bf16 v24, v248, v248
    v_dot2c_f32_bf16 v25, v249, v249
    v_dot2c_f32_bf16 v26, v250, v250
    v_dot2c_f32_bf16 v27, v251, v251
    v_mfma_f32_32x32x16_bf16 v[48:63], v[100:103], v[252:255], v[48:63]
    v_dot2c_f32_bf16 v24, v252, v252
    v_dot2c_f32_bf16 v25, v253, v253
    v_dot2c_f32_bf16 v26, v254, v254
    v_dot2c_f32_bf16 v27, v255, v255
    s_mov_b32 s49, 9216
    v_lshrrev_b32 v28, 3, v1
    v_and_b32 v29, 7, v1
    v_bfe_u32 v30, v1, 4, 1
    v_lshlrev_b32 v30, 2, v30
    v_xor_b32 v29, v29, v30
    v_mul_lo_u32 v28, v28, s49
    v_lshl_add_u32 v2, v29, 4, v28
    s_lshl_b32 s60, s49, 3
    s_sub_u32 s60, s60, 1024
    v_add_u32 v3, s60, v2
    v_add_u32 v4, s60, v3
    s_mul_i32 s53, s49, 192
    s_mul_i32 s54, s49, 24
    s_mul_i32 s95, s92, s53
    s_mul_i32 s96, s93, s53
    s_mul_i32 s97, s94, s53
    s_mul_i32 s37, s40, 442368
    s_add_u32 s45, s37, s51
    s_mov_b32 s44, 0
    v_add_f32 v24, v24, v25
    v_add_f32 v26, v26, v27
    v_add_f32 v24, v24, v26
    v_mov_b32 v25, v24
    s_nop 1
    v_permlane32_swap_b32 v24, v25
    s_nop 1
    v_add_f32 v24, v24, v25
    v_mul_f32 v26, 987991609, v48
    v_cvt_pk_bf16_f32 v27, v26, v26
    v_and_b32 v27, 0xffff0000, v27
    v_xor_b32 v27, 0x80000000, v27
    v_mov_b32 v64, v27
    v_mov_b32 v65, v27
    v_mov_b32 v66, v27
    v_mov_b32 v67, v27
    v_mov_b32 v68, v27
    v_mov_b32 v69, v27
    v_mov_b32 v70, v27
    v_mov_b32 v71, v27
    v_mov_b32 v72, v27
    v_mov_b32 v73, v27
    v_mov_b32 v74, v27
    v_mov_b32 v75, v27
    v_mov_b32 v76, v27
    v_mov_b32 v77, v27
    v_mov_b32 v78, v27
    v_mov_b32 v79, v27
    s_nop 1
    v_mfma_f32_32x32x16_bf16 v[80:95], v[104:107], v[112:115], v[64:79]
    v_mul_f32 v10, 987991609, v24
    v_fma_f32 v10, -v26, v26, v10
    v_max_f32 v10, 0, v10
    v_cvt_pk_bf16_f32 v10, v10, v10
    v_and_b32 v10, 0xffff0000, v10
    v_add_f32 v10, 925353388, v10
    v_cvt_pk_bf16_f32 v10, v10, v10
    v_mfma_f32_32x32x16_bf16 v[80:95], v[108:111], v[116:119], v[80:95]
    v_and_b32 v10, 0xffff0000, v10
    v_sqrt_f32 v10, v10
    v_cmp_gt_u32 vcc, 32, v1
    v_cvt_pk_bf16_f32 v10, v10, v10
    v_and_b32 v11, 0xffff, v10
    v_and_b32 v10, 0xffff0000, v10
    v_rcp_f32 v8, v10
    v_mfma_f32_32x32x16_bf16 v[48:63], v[104:107], v[120:123], v[64:79]
    v_cndmask_b32 v32, 0, v11, vcc
    v_mov_b32 v29, 0x7f800000
    v_mul_f32 v28, 1051597459, v8
    s_cmp_eq_u32 s55, 1
    s_cselect_b64 vcc, -1, 0
    v_cndmask_b32 v10, 0, v28, vcc
    v_cndmask_b32 v11, v29, v28, vcc
    v_mfma_f32_32x32x16_bf16 v[48:63], v[108:111], v[124:127], v[48:63]
    v_mul_f32 v30, v8, v8
    v_lshlrev_b32 v29, 1, v12
    s_lshl_b32 s60, s43, 7
    s_add_u32 s60, s60, 22544384
    s_cmp_eq_u32 s41, 13
    s_cselect_b32 s60, s60, 2147418112
    buffer_store_dword v30, v29, s[12:15], s60 offen sc1
    v_mfma_f32_32x32x16_bf16 v[16:31], v[104:107], v[128:131], v[64:79]
    v_cvt_pk_bf16_f32 v112, v80, v81
    v_cvt_pk_bf16_f32 v113, v82, v83
    v_cvt_pk_bf16_f32 v114, v84, v85
    v_cvt_pk_bf16_f32 v115, v86, v87
    v_mfma_f32_32x32x16_bf16 v[16:31], v[108:111], v[132:135], v[16:31]
    v_cvt_pk_bf16_f32 v116, v88, v89
    v_cvt_pk_bf16_f32 v117, v90, v91
    v_cvt_pk_bf16_f32 v118, v92, v93
    v_cvt_pk_bf16_f32 v119, v94, v95
    v_mfma_f32_32x32x16_bf16 v[80:95], v[104:107], v[136:139], v[64:79]
    v_cvt_pk_bf16_f32 v120, v48, v49
    v_cvt_pk_bf16_f32 v121, v50, v51
    v_cvt_pk_bf16_f32 v122, v52, v53
    v_cvt_pk_bf16_f32 v123, v54, v55
    v_mfma_f32_32x32x16_bf16 v[80:95], v[108:111], v[140:143], v[80:95]
    v_cvt_pk_bf16_f32 v124, v56, v57
    v_cvt_pk_bf16_f32 v125, v58, v59
    v_cvt_pk_bf16_f32 v126, v60, v61
    v_cvt_pk_bf16_f32 v127, v62, v63
    v_mfma_f32_32x32x16_bf16 v[48:63], v[104:107], v[144:147], v[64:79]
    v_cvt_pk_bf16_f32 v128, v16, v17
    v_cvt_pk_bf16_f32 v129, v18, v19
    v_cvt_pk_bf16_f32 v130, v20, v21
    v_cvt_pk_bf16_f32 v131, v22, v23
    v_mfma_f32_32x32x16_bf16 v[48:63], v[108:111], v[148:151], v[48:63]
    v_cvt_pk_bf16_f32 v132, v24, v25
    v_cvt_pk_bf16_f32 v133, v26, v27
    v_cvt_pk_bf16_f32 v134, v28, v29
    v_cvt_pk_bf16_f32 v135, v30, v31
    v_mfma_f32_32x32x16_bf16 v[16:31], v[104:107], v[152:155], v[64:79]
    v_cvt_pk_bf16_f32 v136, v80, v81
    v_cvt_pk_bf16_f32 v137, v82, v83
    v_cvt_pk_bf16_f32 v138, v84, v85
    v_cvt_pk_bf16_f32 v139, v86, v87
    v_mfma_f32_32x32x16_bf16 v[16:31], v[108:111], v[156:159], v[16:31]
    v_cvt_pk_bf16_f32 v140, v88, v89
    v_cvt_pk_bf16_f32 v141, v90, v91
    v_cvt_pk_bf16_f32 v142, v92, v93
    v_cvt_pk_bf16_f32 v143, v94, v95
    v_mfma_f32_32x32x16_bf16 v[80:95], v[104:107], v[160:163], v[64:79]
    v_cvt_pk_bf16_f32 v144, v48, v49
    v_cvt_pk_bf16_f32 v145, v50, v51
    v_cvt_pk_bf16_f32 v146, v52, v53
    v_cvt_pk_bf16_f32 v147, v54, v55
    v_mfma_f32_32x32x16_bf16 v[80:95], v[108:111], v[164:167], v[80:95]
    v_cvt_pk_bf16_f32 v148, v56, v57
    v_cvt_pk_bf16_f32 v149, v58, v59
    v_cvt_pk_bf16_f32 v150, v60, v61
    v_cvt_pk_bf16_f32 v151, v62, v63
    v_mfma_f32_32x32x16_bf16 v[48:63], v[104:107], v[168:171], v[64:79]
    v_cvt_pk_bf16_f32 v152, v16, v17
    v_cvt_pk_bf16_f32 v153, v18, v19
    v_cvt_pk_bf16_f32 v154, v20, v21
    v_cvt_pk_bf16_f32 v155, v22, v23
    v_mfma_f32_32x32x16_bf16 v[48:63], v[108:111], v[172:175], v[48:63]
    v_cvt_pk_bf16_f32 v156, v24, v25
    v_cvt_pk_bf16_f32 v157, v26, v27
    v_cvt_pk_bf16_f32 v158, v28, v29
    v_cvt_pk_bf16_f32 v159, v30, v31
    v_mfma_f32_32x32x16_bf16 v[16:31], v[104:107], v[176:179], v[64:79]
    v_cvt_pk_bf16_f32 v160, v80, v81
    v_cvt_pk_bf16_f32 v161, v82, v83
    v_cvt_pk_bf16_f32 v162, v84, v85
    v_cvt_pk_bf16_f32 v163, v86, v87
    v_mfma_f32_32x32x16_bf16 v[16:31], v[108:111], v[180:183], v[16:31]
    v_cvt_pk_bf16_f32 v164, v88, v89
    v_cvt_pk_bf16_f32 v165, v90, v91
    v_cvt_pk_bf16_f32 v166, v92, v93
    v_cvt_pk_bf16_f32 v167, v94, v95
    v_mfma_f32_32x32x16_bf16 v[80:95], v[104:107], v[184:187], v[64:79]
    v_cvt_pk_bf16_f32 v168, v48, v49
    v_cvt_pk_bf16_f32 v169, v50, v51
    v_cvt_pk_bf16_f32 v170, v52, v53
    v_cvt_pk_bf16_f32 v171, v54, v55
    v_mfma_f32_32x32x16_bf16 v[80:95], v[108:111], v[188:191], v[80:95]
    v_cvt_pk_bf16_f32 v172, v56, v57
    v_cvt_pk_bf16_f32 v173, v58, v59
    v_cvt_pk_bf16_f32 v174, v60, v61
    v_cvt_pk_bf16_f32 v175, v62, v63
    v_mfma_f32_32x32x16_bf16 v[48:63], v[104:107], v[192:195], v[64:79]
    v_cvt_pk_bf16_f32 v176, v16, v17
    v_cvt_pk_bf16_f32 v177, v18, v19
    v_cvt_pk_bf16_f32 v178, v20, v21
    v_cvt_pk_bf16_f32 v179, v22, v23
    v_mfma_f32_32x32x16_bf16 v[48:63], v[108:111], v[196:199], v[48:63]
    v_cvt_pk_bf16_f32 v180, v24, v25
    v_cvt_pk_bf16_f32 v181, v26, v27
    v_cvt_pk_bf16_f32 v182, v28, v29
    v_cvt_pk_bf16_f32 v183, v30, v31
    v_mfma_f32_32x32x16_bf16 v[16:31], v[104:107], v[200:203], v[64:79]
    v_cvt_pk_bf16_f32 v184, v80, v81
    v_cvt_pk_bf16_f32 v185, v82, v83
    v_cvt_pk_bf16_f32 v186, v84, v85
    v_cvt_pk_bf16_f32 v187, v86, v87
    v_mfma_f32_32x32x16_bf16 v[16:31], v[108:111], v[204:207], v[16:31]
    v_cvt_pk_bf16_f32 v188, v88, v89
    v_cvt_pk_bf16_f32 v189, v90, v91
    v_cvt_pk_bf16_f32 v190, v92, v93
    v_cvt_pk_bf16_f32 v191, v94, v95
    v_mfma_f32_32x32x16_bf16 v[80:95], v[104:107], v[208:211], v[64:79]
    v_cvt_pk_bf16_f32 v192, v48, v49
    v_cvt_pk_bf16_f32 v193, v50, v51
    v_cvt_pk_bf16_f32 v194, v52, v53
    v_cvt_pk_bf16_f32 v195, v54, v55
    v_mfma_f32_32x32x16_bf16 v[80:95], v[108:111], v[212:215], v[80:95]
    v_cvt_pk_bf16_f32 v196, v56, v57
    v_cvt_pk_bf16_f32 v197, v58, v59
    v_cvt_pk_bf16_f32 v198, v60, v61
    v_cvt_pk_bf16_f32 v199, v62, v63
    v_mfma_f32_32x32x16_bf16 v[48:63], v[104:107], v[216:219], v[64:79]
    v_cvt_pk_bf16_f32 v200, v16, v17
    v_cvt_pk_bf16_f32 v201, v18, v19
    v_cvt_pk_bf16_f32 v202, v20, v21
    v_cvt_pk_bf16_f32 v203, v22, v23
    v_mfma_f32_32x32x16_bf16 v[48:63], v[108:111], v[220:223], v[48:63]
    v_cvt_pk_bf16_f32 v204, v24, v25
    v_cvt_pk_bf16_f32 v205, v26, v27
    v_cvt_pk_bf16_f32 v206, v28, v29
    v_cvt_pk_bf16_f32 v207, v30, v31
    v_mfma_f32_32x32x16_bf16 v[16:31], v[104:107], v[224:227], v[64:79]
    v_cvt_pk_bf16_f32 v208, v80, v81
    v_cvt_pk_bf16_f32 v209, v82, v83
    v_cvt_pk_bf16_f32 v210, v84, v85
    v_cvt_pk_bf16_f32 v211, v86, v87
    v_mfma_f32_32x32x16_bf16 v[16:31], v[108:111], v[228:231], v[16:31]
    v_cvt_pk_bf16_f32 v212, v88, v89
    v_cvt_pk_bf16_f32 v213, v90, v91
    v_cvt_pk_bf16_f32 v214, v92, v93
    v_cvt_pk_bf16_f32 v215, v94, v95
    v_mfma_f32_32x32x16_bf16 v[80:95], v[104:107], v[232:235], v[64:79]
    v_cvt_pk_bf16_f32 v216, v48, v49
    v_cvt_pk_bf16_f32 v217, v50, v51
    v_cvt_pk_bf16_f32 v218, v52, v53
    v_cvt_pk_bf16_f32 v219, v54, v55
    v_mfma_f32_32x32x16_bf16 v[80:95], v[108:111], v[236:239], v[80:95]
    v_cvt_pk_bf16_f32 v220, v56, v57
    v_cvt_pk_bf16_f32 v221, v58, v59
    v_cvt_pk_bf16_f32 v222, v60, v61
    v_cvt_pk_bf16_f32 v223, v62, v63
    v_mfma_f32_32x32x16_bf16 v[48:63], v[104:107], v[240:243], v[64:79]
    v_cvt_pk_bf16_f32 v224, v16, v17
    v_cvt_pk_bf16_f32 v225, v18, v19
    v_cvt_pk_bf16_f32 v226, v20, v21
    v_cvt_pk_bf16_f32 v227, v22, v23
    v_mfma_f32_32x32x16_bf16 v[48:63], v[108:111], v[244:247], v[48:63]
    v_cvt_pk_bf16_f32 v228, v24, v25
    v_cvt_pk_bf16_f32 v229, v26, v27
    v_cvt_pk_bf16_f32 v230, v28, v29
    v_cvt_pk_bf16_f32 v231, v30, v31
    v_mfma_f32_32x32x16_bf16 v[16:31], v[104:107], v[248:251], v[64:79]
    v_cvt_pk_bf16_f32 v232, v80, v81
    v_cvt_pk_bf16_f32 v233, v82, v83
    v_cvt_pk_bf16_f32 v234, v84, v85
    v_cvt_pk_bf16_f32 v235, v86, v87
    v_mfma_f32_32x32x16_bf16 v[16:31], v[108:111], v[252:255], v[16:31]
    v_cvt_pk_bf16_f32 v236, v88, v89
    v_cvt_pk_bf16_f32 v237, v90, v91
    v_cvt_pk_bf16_f32 v238, v92, v93
    v_cvt_pk_bf16_f32 v239, v94, v95
    s_nop 2
    v_cvt_pk_bf16_f32 v240, v48, v49
    v_cvt_pk_bf16_f32 v241, v50, v51
    v_cvt_pk_bf16_f32 v242, v52, v53
    v_cvt_pk_bf16_f32 v243, v54, v55
    v_cvt_pk_bf16_f32 v244, v56, v57
    v_cvt_pk_bf16_f32 v245, v58, v59
    v_cvt_pk_bf16_f32 v246, v60, v61
    v_cvt_pk_bf16_f32 v247, v62, v63
    s_nop 3
    v_cvt_pk_bf16_f32 v248, v16, v17
    v_cvt_pk_bf16_f32 v249, v18, v19
    v_cvt_pk_bf16_f32 v250, v20, v21
    v_cvt_pk_bf16_f32 v251, v22, v23
    v_cvt_pk_bf16_f32 v252, v24, v25
    v_cvt_pk_bf16_f32 v253, v26, v27
    v_cvt_pk_bf16_f32 v254, v28, v29
    v_cvt_pk_bf16_f32 v255, v30, v31
    s_waitcnt vmcnt(3)
    s_setprio 3
    s_waitcnt lgkmcnt(0)
    s_mov_b64 exec, 1
    ds_add_u32 v15, v14
    s_mov_b64 exec, -1
    s_add_u32 s66, s66, 4
    v_add_u32 v6, s46, v5
    v_xor_b32 v7, 64, v6
    s_add_u32 s46, s46, 24576
    s_cmp_ge_u32 s46, 98304
    s_cselect_b32 s46, 0, s46
g_pfirst:
    ds_read_b32 v13, v15
    s_waitcnt lgkmcnt(0)
    v_readfirstlane_b32 s60, v13
    s_cmp_ge_u32 s60, s66
    s_cbranch_scc0 g_pfirst
    ds_read_b64_tr_b16 v[16:17], v6 offset:0
    ds_read_b64_tr_b16 v[18:19], v6 offset:1024
    ds_read_b64_tr_b16 v[20:21], v7 offset:0
    ds_read_b64_tr_b16 v[22:23], v7 offset:1024
    ds_read_b64_tr_b16 v[24:25], v6 offset:2048
    ds_read_b64_tr_b16 v[26:27], v6 offset:3072
    ds_read_b64_tr_b16 v[28:29], v7 offset:2048
    ds_read_b64_tr_b16 v[30:31], v7 offset:3072
    ds_read_b64_tr_b16 v[40:41], v6 offset:4096
    ds_read_b64_tr_b16 v[42:43], v6 offset:5120
    s_mov_b32 s98, 2147418112
g1_loop:
    s_add_u32 s60, s44, 1
    s_cmp_eq_u32 s60, s67
    s_mov_b32 s99, 0
    s_cbranch_scc1 g_sw2
g_sw2_ret0:
    v_mfma_f32_32x32x8_bf16 v[48:63], v[36:37], v[32:33], 0
    v_mfma_f32_32x32x8_bf16 v[64:79], v[38:39], v[32:33], 0
    s_waitcnt lgkmcnt(8)
    v_mfma_f32_32x32x16_bf16 v[48:63], v[16:19], v[112:115], v[48:63]
    ds_read_b64_tr_b16 v[44:45], v7 offset:4096
    ds_read_b64_tr_b16 v[46:47], v7 offset:5120
    buffer_load_ushort v36, v12, s[16:19], s51 offen
    s_waitcnt lgkmcnt(8)
    v_mfma_f32_32x32x16_bf16 v[64:79], v[20:23], v[112:115], v[64:79]
    ds_read_b64_tr_b16 v[16:17], v6 offset:6144
    ds_read_b64_tr_b16 v[18:19], v6 offset:7168
    buffer_load_ushort v38, v12, s[16:19], s51 offen offset:64
    s_waitcnt lgkmcnt(8)
    v_mfma_f32_32x32x16_bf16 v[48:63], v[24:27], v[116:119], v[48:63]
    ds_read_b64_tr_b16 v[20:21], v7 offset:6144
    ds_read_b64_tr_b16 v[22:23], v7 offset:7168
    s_waitcnt lgkmcnt(8)
    v_mfma_f32_32x32x16_bf16 v[64:79], v[28:31], v[116:119], v[64:79]
    ds_read_b64_tr_b16 v[24:25], v6 offset:8192
    ds_read_b64_tr_b16 v[26:27], v6 offset:9216
    v_med3_f32 v34, v80, v10, v11
    v_mul_f32 v80, v34, v80
    s_waitcnt lgkmcnt(8)
    v_mfma_f32_32x32x16_bf16 v[48:63], v[40:43], v[120:123], v[48:63]
    ds_read_b64_tr_b16 v[28:29], v7 offset:8192
    ds_read_b64_tr_b16 v[30:31], v7 offset:9216
    v_med3_f32 v34, v81, v10, v11
    v_mul_f32 v81, v34, v81
    s_waitcnt lgkmcnt(8)
    v_mfma_f32_32x32x16_bf16 v[64:79], v[44:47], v[120:123], v[64:79]
    ds_read_b64_tr_b16 v[40:41], v6 offset:10240
    ds_read_b64_tr_b16 v[42:43], v6 offset:11264
    v_cvt_pk_bf16_f32 v80, v80, v81
    s_waitcnt lgkmcnt(8)
    v_mfma_f32_32x32x16_bf16 v[48:63], v[16:19], v[124:127], v[48:63]
    ds_read_b64_tr_b16 v[44:45], v7 offset:10240
    ds_read_b64_tr_b16 v[46:47], v7 offset:11264
    v_med3_f32 v34, v82, v10, v11
    v_mul_f32 v82, v34, v82
    s_waitcnt lgkmcnt(8)
    v_mfma_f32_32x32x16_bf16 v[64:79], v[20:23], v[124:127], v[64:79]
    ds_read_b64_tr_b16 v[16:17], v6 offset:12288
    ds_read_b64_tr_b16 v[18:19], v6 offset:13312
    v_med3_f32 v34, v83, v10, v11
    v_mul_f32 v83, v34, v83
    s_waitcnt lgkmcnt(8)
    v_mfma_f32_32x32x16_bf16 v[48:63], v[24:27], v[128:131], v[48:63]
    s_waitcnt vmcnt(10)
    s_mov_b64 exec, 1
    ds_add_u32 v15, v14
    s_mov_b64 exec, -1
    s_add_u32 s66, s66, 4
    ds_read_b64_tr_b16 v[20:21], v7 offset:12288
    ds_read_b64_tr_b16 v[22:23], v7 offset:13312
    v_cvt_pk_bf16_f32 v81, v82, v83
    s_waitcnt lgkmcnt(9)
    v_mfma_f32_32x32x16_bf16 v[64:79], v[28:31], v[128:131], v[64:79]
    ds_read_b64_tr_b16 v[24:25], v6 offset:14336
    ds_read_b64_tr_b16 v[26:27], v6 offset:15360
    s_waitcnt lgkmcnt(9)
    v_mfma_f32_32x32x16_bf16 v[48:63], v[40:43], v[132:135], v[48:63]
    ds_read_b64_tr_b16 v[28:29], v7 offset:14336
    ds_read_b64_tr_b16 v[30:31], v7 offset:15360
    v_med3_f32 v34, v84, v10, v11
    v_mul_f32 v84, v34, v84
    s_waitcnt lgkmcnt(9)
    v_mfma_f32_32x32x16_bf16 v[64:79], v[44:47], v[132:135], v[64:79]
    ds_read_b64_tr_b16 v[40:41], v6 offset:16384
    ds_read_b64_tr_b16 v[42:43], v6 offset:17408
    v_med3_f32 v34, v85, v10, v11
    v_mul_f32 v85, v34, v85
    s_waitcnt lgkmcnt(9)
    v_mfma_f32_32x32x16_bf16 v[48:63], v[16:19], v[136:139], v[48:63]
    ds_read_b64_tr_b16 v[44:45], v7 offset:16384
    ds_read_b64_tr_b16 v[46:47], v7 offset:17408
    v_cvt_pk_bf16_f32 v82, v84, v85
    s_waitcnt lgkmcnt(8)
    v_mfma_f32_32x32x16_bf16 v[64:79], v[20:23], v[136:139], v[64:79]
    ds_read_b32 v13, v15
    ds_read_b64_tr_b16 v[16:17], v6 offset:18432
    ds_read_b64_tr_b16 v[18:19], v6 offset:19456
    v_med3_f32 v34, v86, v10, v11
    v_mul_f32 v86, v34, v86
    s_waitcnt lgkmcnt(9)
    v_mfma_f32_32x32x16_bf16 v[48:63], v[24:27], v[140:143], v[48:63]
    ds_read_b64_tr_b16 v[20:21], v7 offset:18432
    ds_read_b64_tr_b16 v[22:23], v7 offset:19456
    v_med3_f32 v34, v87, v10, v11
    v_mul_f32 v87, v34, v87
    s_waitcnt lgkmcnt(9)
    v_mfma_f32_32x32x16_bf16 v[64:79], v[28:31], v[140:143], v[64:79]
    ds_read_b64_tr_b16 v[24:25], v6 offset:20480
    ds_read_b64_tr_b16 v[26:27], v6 offset:21504
    s_waitcnt lgkmcnt(9)
    v_mfma_f32_32x32x16_bf16 v[48:63], v[40:43], v[144:147], v[48:63]
    ds_read_b64_tr_b16 v[28:29], v7 offset:20480
    ds_read_b64_tr_b16 v[30:31], v7 offset:21504
    v_cvt_pk_bf16_f32 v83, v86, v87
    s_waitcnt lgkmcnt(9)
    v_mfma_f32_32x32x16_bf16 v[64:79], v[44:47], v[144:147], v[64:79]
    s_waitcnt lgkmcnt(8)
    v_readfirstlane_b32 s60, v13
    s_cmp_lt_u32 s60, s66
    s_cbranch_scc1 g1_poll00
g1_poll00_ret:
    ds_read_b64_tr_b16 v[40:41], v6 offset:22528
    ds_read_b64_tr_b16 v[42:43], v6 offset:23552
    s_add_u32 m0, s47, 0
    s_add_u32 s61, s45, s95
    v_med3_f32 v34, v88, v10, v11
    v_mul_f32 v88, v34, v88
    s_waitcnt lgkmcnt(8)
    v_mfma_f32_32x32x16_bf16 v[48:63], v[16:19], v[148:151], v[48:63]
    ds_read_b64_tr_b16 v[44:45], v7 offset:22528
    ds_read_b64_tr_b16 v[46:47], v7 offset:23552
    buffer_load_dwordx4 v2, s[8:11], s61 offen offset:0 lds
    v_med3_f32 v34, v89, v10, v11
    v_mul_f32 v89, v34, v89
    s_waitcnt lgkmcnt(8)
    v_mfma_f32_32x32x16_bf16 v[64:79], v[20:23], v[148:151], v[64:79]
    v_add_u32 v6, s46, v5
    v_xor_b32 v7, 64, v6
    s_add_u32 s46, s46, 24576
    s_cmp_ge_u32 s46, 98304
    s_cselect_b32 s46, 0, s46
    ds_read_b64_tr_b16 v[16:17], v6 offset:0
    ds_read_b64_tr_b16 v[18:19], v6 offset:1024
    buffer_load_dwordx4 v3, s[8:11], s61 offen offset:1024 lds
    v_cvt_pk_bf16_f32 v84, v88, v89
    s_waitcnt lgkmcnt(8)
    v_mfma_f32_32x32x16_bf16 v[48:63], v[24:27], v[152:155], v[48:63]
    ds_read_b64_tr_b16 v[20:21], v7 offset:0
    ds_read_b64_tr_b16 v[22:23], v7 offset:1024
    buffer_load_dwordx4 v4, s[8:11], s61 offen offset:2048 lds
    s_add_u32 m0, s47, 3072
    s_add_u32 s61, s61, s54
    v_med3_f32 v34, v90, v10, v11
    v_mul_f32 v90, v34, v90
    s_waitcnt lgkmcnt(8)
    v_mfma_f32_32x32x16_bf16 v[64:79], v[28:31], v[152:155], v[64:79]
    ds_read_b64_tr_b16 v[24:25], v6 offset:2048
    ds_read_b64_tr_b16 v[26:27], v6 offset:3072
    buffer_load_dwordx4 v2, s[8:11], s61 offen offset:0 lds
    s_waitcnt lgkmcnt(8)
    v_mfma_f32_32x32x16_bf16 v[48:63], v[40:43], v[156:159], v[48:63]
    ds_read_b64_tr_b16 v[28:29], v7 offset:2048
    ds_read_b64_tr_b16 v[30:31], v7 offset:3072
    buffer_load_dwordx4 v3, s[8:11], s61 offen offset:1024 lds
    v_med3_f32 v34, v91, v10, v11
    v_mul_f32 v91, v34, v91
    s_waitcnt lgkmcnt(8)
    v_mfma_f32_32x32x16_bf16 v[64:79], v[44:47], v[156:159], v[64:79]
    ds_read_b64_tr_b16 v[40:41], v6 offset:4096
    ds_read_b64_tr_b16 v[42:43], v6 offset:5120
    buffer_load_dwordx4 v4, s[8:11], s61 offen offset:2048 lds
    s_add_u32 s47, s47, 24576
    s_cmp_ge_u32 s47, 98304
    s_cselect_b32 s61, 98304, 0
    s_sub_u32 s47, s47, s61
    v_cvt_pk_bf16_f32 v85, v90, v91
    s_waitcnt lgkmcnt(8)
    v_mfma_f32_32x32x16_bf16 v[48:63], v[16:19], v[160:163], v[48:63]
    ds_read_b64_tr_b16 v[44:45], v7 offset:4096
    ds_read_b64_tr_b16 v[46:47], v7 offset:5120
    v_med3_f32 v34, v92, v10, v11
    v_mul_f32 v92, v34, v92
    s_waitcnt lgkmcnt(8)
    v_mfma_f32_32x32x16_bf16 v[64:79], v[20:23], v[160:163], v[64:79]
    ds_read_b64_tr_b16 v[16:17], v6 offset:6144
    ds_read_b64_tr_b16 v[18:19], v6 offset:7168
    v_med3_f32 v34, v93, v10, v11
    v_mul_f32 v93, v34, v93
    s_waitcnt lgkmcnt(8)
    v_mfma_f32_32x32x16_bf16 v[48:63], v[24:27], v[164:167], v[48:63]
    ds_read_b64_tr_b16 v[20:21], v7 offset:6144
    ds_read_b64_tr_b16 v[22:23], v7 offset:7168
    v_cvt_pk_bf16_f32 v86, v92, v93
    s_waitcnt lgkmcnt(8)
    v_mfma_f32_32x32x16_bf16 v[64:79], v[28:31], v[164:167], v[64:79]
    ds_read_b64_tr_b16 v[24:25], v6 offset:8192
    ds_read_b64_tr_b16 v[26:27], v6 offset:9216
    s_waitcnt lgkmcnt(8)
    v_mfma_f32_32x32x16_bf16 v[48:63], v[40:43], v[168:171], v[48:63]
    ds_read_b64_tr_b16 v[28:29], v7 offset:8192
    ds_read_b64_tr_b16 v[30:31], v7 offset:9216
    v_med3_f32 v34, v94, v10, v11
    v_mul_f32 v94, v34, v94
    s_waitcnt lgkmcnt(8)
    v_mfma_f32_32x32x16_bf16 v[64:79], v[44:47], v[168:171], v[64:79]
    ds_read_b64_tr_b16 v[40:41], v6 offset:10240
    ds_read_b64_tr_b16 v[42:43], v6 offset:11264
    v_med3_f32 v34, v95, v10, v11
    v_mul_f32 v95, v34, v95
    s_waitcnt lgkmcnt(8)
    v_mfma_f32_32x32x16_bf16 v[48:63], v[16:19], v[172:175], v[48:63]
    ds_read_b64_tr_b16 v[44:45], v7 offset:10240
    ds_read_b64_tr_b16 v[46:47], v7 offset:11264
    v_cvt_pk_bf16_f32 v87, v94, v95
    s_waitcnt lgkmcnt(8)
    v_mfma_f32_32x32x16_bf16 v[64:79], v[20:23], v[172:175], v[64:79]
    ds_read_b64_tr_b16 v[16:17], v6 offset:12288
    ds_read_b64_tr_b16 v[18:19], v6 offset:13312
    buffer_store_dwordx4 v[80:83], v9, s[12:15], s98 offen offset:0 sc1
    s_waitcnt lgkmcnt(8)
    v_mfma_f32_32x32x16_bf16 v[48:63], v[24:27], v[176:179], v[48:63]
    s_waitcnt vmcnt(9)
    s_mov_b64 exec, 1
    ds_add_u32 v15, v14
    s_mov_b64 exec, -1
    s_add_u32 s66, s66, 4
    ds_read_b64_tr_b16 v[20:21], v7 offset:12288
    ds_read_b64_tr_b16 v[22:23], v7 offset:13312
    buffer_store_dwordx4 v[84:87], v9, s[12:15], s98 offen offset:1024 sc1
    s_waitcnt lgkmcnt(9)
    v_mfma_f32_32x32x16_bf16 v[64:79], v[28:31], v[176:179], v[64:79]
    ds_read_b64_tr_b16 v[24:25], v6 offset:14336
    ds_read_b64_tr_b16 v[26:27], v6 offset:15360
    s_waitcnt lgkmcnt(9)
    v_mfma_f32_32x32x16_bf16 v[48:63], v[40:43], v[180:183], v[48:63]
    ds_read_b64_tr_b16 v[28:29], v7 offset:14336
    ds_read_b64_tr_b16 v[30:31], v7 offset:15360
    v_med3_f32 v34, v96, v10, v11
    v_mul_f32 v96, v34, v96
    s_waitcnt lgkmcnt(9)
    v_mfma_f32_32x32x16_bf16 v[64:79], v[44:47], v[180:183], v[64:79]
    ds_read_b64_tr_b16 v[40:41], v6 offset:16384
    ds_read_b64_tr_b16 v[42:43], v6 offset:17408
    v_med3_f32 v34, v97, v10, v11
    v_mul_f32 v97, v34, v97
    s_waitcnt lgkmcnt(9)
    v_mfma_f32_32x32x16_bf16 v[48:63], v[16:19], v[184:187], v[48:63]
    ds_read_b64_tr_b16 v[44:45], v7 offset:16384
    ds_read_b64_tr_b16 v[46:47], v7 offset:17408
    v_cvt_pk_bf16_f32 v96, v96, v97
    s_waitcnt lgkmcnt(8)
    v_mfma_f32_32x32x16_bf16 v[64:79], v[20:23], v[184:187], v[64:79]
    ds_read_b32 v13, v15
    ds_read_b64_tr_b16 v[16:17], v6 offset:18432
    ds_read_b64_tr_b16 v[18:19], v6 offset:19456
    v_med3_f32 v34, v98, v10, v11
    v_mul_f32 v98, v34, v98
    s_waitcnt lgkmcnt(9)
    v_mfma_f32_32x32x16_bf16 v[48:63], v[24:27], v[188:191], v[48:63]
    ds_read_b64_tr_b16 v[20:21], v7 offset:18432
    ds_read_b64_tr_b16 v[22:23], v7 offset:19456
    v_med3_f32 v34, v99, v10, v11
    v_mul_f32 v99, v34, v99
    s_waitcnt lgkmcnt(9)
    v_mfma_f32_32x32x16_bf16 v[64:79], v[28:31], v[188:191], v[64:79]
    ds_read_b64_tr_b16 v[24:25], v6 offset:20480
    ds_read_b64_tr_b16 v[26:27], v6 offset:21504
    v_cvt_pk_bf16_f32 v97, v98, v99
    s_waitcnt lgkmcnt(9)
    v_mfma_f32_32x32x16_bf16 v[48:63], v[40:43], v[192:195], v[48:63]
    ds_read_b64_tr_b16 v[28:29], v7 offset:20480
    ds_read_b64_tr_b16 v[30:31], v7 offset:21504
    s_waitcnt lgkmcnt(9)
    v_mfma_f32_32x32x16_bf16 v[64:79], v[44:47], v[192:195], v[64:79]
    s_waitcnt lgkmcnt(8)
    v_readfirstlane_b32 s60, v13
    s_cmp_lt_u32 s60, s66
    s_cbranch_scc1 g1_poll01
g1_poll01_ret:
    ds_read_b64_tr_b16 v[40:41], v6 offset:22528
    ds_read_b64_tr_b16 v[42:43], v6 offset:23552
    s_add_u32 m0, s47, 0
    s_add_u32 s61, s45, s96
    v_med3_f32 v34, v100, v10, v11
    v_mul_f32 v100, v34, v100
    s_waitcnt lgkmcnt(8)
    v_mfma_f32_32x32x16_bf16 v[48:63], v[16:19], v[196:199], v[48:63]
    ds_read_b64_tr_b16 v[44:45], v7 offset:22528
    ds_read_b64_tr_b16 v[46:47], v7 offset:23552
    buffer_load_dwordx4 v2, s[8:11], s61 offen offset:0 lds
    v_med3_f32 v34, v101, v10, v11
    v_mul_f32 v101, v34, v101
    s_waitcnt lgkmcnt(8)
    v_mfma_f32_32x32x16_bf16 v[64:79], v[20:23], v[196:199], v[64:79]
    v_add_u32 v6, s46, v5
    v_xor_b32 v7, 64, v6
    s_add_u32 s46, s46, 24576
    s_cmp_ge_u32 s46, 98304
    s_cselect_b32 s46, 0, s46
    ds_read_b64_tr_b16 v[16:17], v6 offset:0
    ds_read_b64_tr_b16 v[18:19], v6 offset:1024
    buffer_load_dwordx4 v3, s[8:11], s61 offen offset:1024 lds
    v_cvt_pk_bf16_f32 v98, v100, v101
    s_waitcnt lgkmcnt(8)
    v_mfma_f32_32x32x16_bf16 v[48:63], v[24:27], v[200:203], v[48:63]
    ds_read_b64_tr_b16 v[20:21], v7 offset:0
    ds_read_b64_tr_b16 v[22:23], v7 offset:1024
    buffer_load_dwordx4 v4, s[8:11], s61 offen offset:2048 lds
    s_add_u32 m0, s47, 3072
    s_add_u32 s61, s61, s54
    v_med3_f32 v34, v102, v10, v11
    v_mul_f32 v102, v34, v102
    s_waitcnt lgkmcnt(8)
    v_mfma_f32_32x32x16_bf16 v[64:79], v[28:31], v[200:203], v[64:79]
    ds_read_b64_tr_b16 v[24:25], v6 offset:2048
    ds_read_b64_tr_b16 v[26:27], v6 offset:3072
    buffer_load_dwordx4 v2, s[8:11], s61 offen offset:0 lds
    v_med3_f32 v34, v103, v10, v11
    v_mul_f32 v103, v34, v103
    s_waitcnt lgkmcnt(8)
    v_mfma_f32_32x32x16_bf16 v[48:63], v[40:43], v[204:207], v[48:63]
    ds_read_b64_tr_b16 v[28:29], v7 offset:2048
    ds_read_b64_tr_b16 v[30:31], v7 offset:3072
    buffer_load_dwordx4 v3, s[8:11], s61 offen offset:1024 lds
    s_waitcnt lgkmcnt(8)
    v_mfma_f32_32x32x16_bf16 v[64:79], v[44:47], v[204:207], v[64:79]
    ds_read_b64_tr_b16 v[40:41], v6 offset:4096
    ds_read_b64_tr_b16 v[42:43], v6 offset:5120
    buffer_load_dwordx4 v4, s[8:11], s61 offen offset:2048 lds
    s_add_u32 s47, s47, 24576
    s_cmp_ge_u32 s47, 98304
    s_cselect_b32 s61, 98304, 0
    s_sub_u32 s47, s47, s61
    v_cvt_pk_bf16_f32 v99, v102, v103
    s_waitcnt lgkmcnt(8)
    v_mfma_f32_32x32x16_bf16 v[48:63], v[16:19], v[208:211], v[48:63]
    ds_read_b64_tr_b16 v[44:45], v7 offset:4096
    ds_read_b64_tr_b16 v[46:47], v7 offset:5120
    v_med3_f32 v34, v104, v10, v11
    v_mul_f32 v104, v34, v104
    s_waitcnt lgkmcnt(8)
    v_mfma_f32_32x32x16_bf16 v[64:79], v[20:23], v[208:211], v[64:79]
    ds_read_b64_tr_b16 v[16:17], v6 offset:6144
    ds_read_b64_tr_b16 v[18:19], v6 offset:7168
    v_med3_f32 v34, v105, v10, v11
    v_mul_f32 v105, v34, v105
    s_waitcnt lgkmcnt(8)
    v_mfma_f32_32x32x16_bf16 v[48:63], v[24:27], v[212:215], v[48:63]
    ds_read_b64_tr_b16 v[20:21], v7 offset:6144
    ds_read_b64_tr_b16 v[22:23], v7 offset:7168
    v_cvt_pk_bf16_f32 v100, v104, v105
    s_waitcnt lgkmcnt(8)
    v_mfma_f32_32x32x16_bf16 v[64:79], v[28:31], v[212:215], v[64:79]
    ds_read_b64_tr_b16 v[24:25], v6 offset:8192
    ds_read_b64_tr_b16 v[26:27], v6 offset:9216
    v_med3_f32 v34, v106, v10, v11
    v_mul_f32 v106, v34, v106
    s_waitcnt lgkmcnt(8)
    v_mfma_f32_32x32x16_bf16 v[48:63], v[40:43], v[216:219], v[48:63]
    ds_read_b64_tr_b16 v[28:29], v7 offset:8192
    ds_read_b64_tr_b16 v[30:31], v7 offset:9216
    s_waitcnt lgkmcnt(8)
    v_mfma_f32_32x32x16_bf16 v[64:79], v[44:47], v[216:219], v[64:79]
    ds_read_b64_tr_b16 v[40:41], v6 offset:10240
    ds_read_b64_tr_b16 v[42:43], v6 offset:11264
    v_med3_f32 v34, v107, v10, v11
    v_mul_f32 v107, v34, v107
    s_waitcnt lgkmcnt(8)
    v_mfma_f32_32x32x16_bf16 v[48:63], v[16:19], v[220:223], v[48:63]
    ds_read_b64_tr_b16 v[44:45], v7 offset:10240
    ds_read_b64_tr_b16 v[46:47], v7 offset:11264
    v_cvt_pk_bf16_f32 v101, v106, v107
    s_waitcnt lgkmcnt(8)
    v_mfma_f32_32x32x16_bf16 v[64:79], v[20:23], v[220:223], v[64:79]
    ds_read_b64_tr_b16 v[16:17], v6 offset:12288
    ds_read_b64_tr_b16 v[18:19], v6 offset:13312
    v_med3_f32 v34, v108, v10, v11
    v_mul_f32 v108, v34, v108
    s_waitcnt lgkmcnt(8)
    v_mfma_f32_32x32x16_bf16 v[48:63], v[24:27], v[224:227], v[48:63]
    s_waitcnt vmcnt(8)
    s_mov_b64 exec, 1
    ds_add_u32 v15, v14
    s_mov_b64 exec, -1
    s_add_u32 s66, s66, 4
    ds_read_b64_tr_b16 v[20:21], v7 offset:12288
    ds_read_b64_tr_b16 v[22:23], v7 offset:13312
    v_med3_f32 v34, v109, v10, v11
    v_mul_f32 v109, v34, v109
    s_waitcnt lgkmcnt(9)
    v_mfma_f32_32x32x16_bf16 v[64:79], v[28:31], v[224:227], v[64:79]
    ds_read_b64_tr_b16 v[24:25], v6 offset:14336
    ds_read_b64_tr_b16 v[26:27], v6 offset:15360
    v_cvt_pk_bf16_f32 v102, v108, v109
    s_waitcnt lgkmcnt(9)
    v_mfma_f32_32x32x16_bf16 v[48:63], v[40:43], v[228:231], v[48:63]
    ds_read_b64_tr_b16 v[28:29], v7 offset:14336
    ds_read_b64_tr_b16 v[30:31], v7 offset:15360
    s_waitcnt lgkmcnt(9)
    v_mfma_f32_32x32x16_bf16 v[64:79], v[44:47], v[228:231], v[64:79]
    ds_read_b64_tr_b16 v[40:41], v6 offset:16384
    ds_read_b64_tr_b16 v[42:43], v6 offset:17408
    v_med3_f32 v34, v110, v10, v11
    v_mul_f32 v110, v34, v110
    s_waitcnt lgkmcnt(9)
    v_mfma_f32_32x32x16_bf16 v[48:63], v[16:19], v[232:235], v[48:63]
    ds_read_b64_tr_b16 v[44:45], v7 offset:16384
    ds_read_b64_tr_b16 v[46:47], v7 offset:17408
    v_med3_f32 v34, v111, v10, v11
    v_mul_f32 v111, v34, v111
    s_waitcnt lgkmcnt(8)
    v_mfma_f32_32x32x16_bf16 v[64:79], v[20:23], v[232:235], v[64:79]
    ds_read_b32 v13, v15
    ds_read_b64_tr_b16 v[16:17], v6 offset:18432
    ds_read_b64_tr_b16 v[18:19], v6 offset:19456
    v_cvt_pk_bf16_f32 v103, v110, v111
    s_waitcnt lgkmcnt(9)
    v_mfma_f32_32x32x16_bf16 v[48:63], v[24:27], v[236:239], v[48:63]
    ds_read_b64_tr_b16 v[20:21], v7 offset:18432
    ds_read_b64_tr_b16 v[22:23], v7 offset:19456
    buffer_store_dwordx4 v[96:99], v9, s[12:15], s98 offen offset:2048 sc1
    s_waitcnt lgkmcnt(9)
    v_mfma_f32_32x32x16_bf16 v[64:79], v[28:31], v[236:239], v[64:79]
    ds_read_b64_tr_b16 v[24:25], v6 offset:20480
    ds_read_b64_tr_b16 v[26:27], v6 offset:21504
    buffer_store_dwordx4 v[100:103], v9, s[12:15], s98 offen offset:3072 sc1
    s_waitcnt lgkmcnt(9)
    v_mfma_f32_32x32x16_bf16 v[48:63], v[40:43], v[240:243], v[48:63]
    ds_read_b64_tr_b16 v[28:29], v7 offset:20480
    ds_read_b64_tr_b16 v[30:31], v7 offset:21504
    s_waitcnt lgkmcnt(9)
    v_mfma_f32_32x32x16_bf16 v[64:79], v[44:47], v[240:243], v[64:79]
    s_waitcnt lgkmcnt(8)
    v_readfirstlane_b32 s60, v13
    s_cmp_lt_u32 s60, s66
    s_cbranch_scc1 g1_poll02
g1_poll02_ret:
    ds_read_b64_tr_b16 v[40:41], v6 offset:22528
    ds_read_b64_tr_b16 v[42:43], v6 offset:23552
    s_add_u32 m0, s47, 0
    s_add_u32 s61, s45, s97
    s_waitcnt lgkmcnt(8)
    v_mfma_f32_32x32x16_bf16 v[48:63], v[16:19], v[244:247], v[48:63]
    ds_read_b64_tr_b16 v[44:45], v7 offset:22528
    ds_read_b64_tr_b16 v[46:47], v7 offset:23552
    buffer_load_dwordx4 v2, s[8:11], s61 offen offset:0 lds
    s_waitcnt lgkmcnt(8)
    v_mfma_f32_32x32x16_bf16 v[64:79], v[20:23], v[244:247], v[64:79]
    v_add_u32 v6, s46, v5
    v_xor_b32 v7, 64, v6
    s_add_u32 s46, s46, 24576
    s_cmp_ge_u32 s46, 98304
    s_cselect_b32 s46, 0, s46
    ds_read_b64_tr_b16 v[16:17], v6 offset:0
    ds_read_b64_tr_b16 v[18:19], v6 offset:1024
    buffer_load_dwordx4 v3, s[8:11], s61 offen offset:1024 lds
    s_waitcnt lgkmcnt(8)
    v_mfma_f32_32x32x16_bf16 v[48:63], v[24:27], v[248:251], v[48:63]
    ds_read_b64_tr_b16 v[20:21], v7 offset:0
    ds_read_b64_tr_b16 v[22:23], v7 offset:1024
    buffer_load_dwordx4 v4, s[8:11], s61 offen offset:2048 lds
    s_add_u32 m0, s47, 3072
    s_add_u32 s61, s61, s54
    s_waitcnt lgkmcnt(8)
    v_mfma_f32_32x32x16_bf16 v[64:79], v[28:31], v[248:251], v[64:79]
    ds_read_b64_tr_b16 v[24:25], v6 offset:2048
    ds_read_b64_tr_b16 v[26:27], v6 offset:3072
    buffer_load_dwordx4 v2, s[8:11], s61 offen offset:0 lds
    s_waitcnt lgkmcnt(8)
    v_mfma_f32_32x32x16_bf16 v[48:63], v[40:43], v[252:255], v[48:63]
    ds_read_b64_tr_b16 v[28:29], v7 offset:2048
    ds_read_b64_tr_b16 v[30:31], v7 offset:3072
    buffer_load_dwordx4 v3, s[8:11], s61 offen offset:1024 lds
    s_waitcnt lgkmcnt(8)
    v_mfma_f32_32x32x16_bf16 v[64:79], v[44:47], v[252:255], v[64:79]
    ds_read_b64_tr_b16 v[40:41], v6 offset:4096
    ds_read_b64_tr_b16 v[42:43], v6 offset:5120
    buffer_load_dwordx4 v4, s[8:11], s61 offen offset:2048 lds
    s_add_u32 s47, s47, 24576
    s_cmp_ge_u32 s47, 98304
    s_cselect_b32 s61, 98304, 0
    s_sub_u32 s47, s47, s61
    s_mov_b32 s98, s50
    s_lshr_b32 s60, s51, 5
    s_add_u32 s60, s60, 36
    s_add_u32 s60, s60, s68
    s_lshl_b32 s50, s60, 10
    s_and_b32 s60, s48, 31
    s_lshl_b32 s60, s60, 7
    s_add_u32 s51, s60, s36
    s_lshr_b32 s48, s48, 5
    s_add_u32 s45, s37, s51
    s_lshl_b32 s60, s44, 2
    s_add_u32 s60, s60, s55
    s_sub_u32 s60, s60, 1
    s_cmp_lt_u32 s60, 2
    s_cbranch_scc1 g_ep0
g_ep0_ret:
    s_add_u32 s44, s44, 1
    s_cmp_ge_u32 s44, s67
    s_cbranch_scc1 g1_end0
    s_add_u32 s60, s44, 1
    s_cmp_eq_u32 s60, s67
    s_mov_b32 s99, 1
    s_cbranch_scc1 g_sw2
g_sw2_ret1:
    v_mfma_f32_32x32x8_bf16 v[80:95], v[36:37], v[32:33], 0
    v_mfma_f32_32x32x8_bf16 v[96:111], v[38:39], v[32:33], 0
    s_waitcnt lgkmcnt(8)
    v_mfma_f32_32x32x16_bf16 v[80:95], v[16:19], v[112:115], v[80:95]
    ds_read_b64_tr_b16 v[44:45], v7 offset:4096
    ds_read_b64_tr_b16 v[46:47], v7 offset:5120
    buffer_load_ushort v36, v12, s[16:19], s51 offen
    s_waitcnt lgkmcnt(8)
    v_mfma_f32_32x32x16_bf16 v[96:111], v[20:23], v[112:115], v[96:111]
    ds_read_b64_tr_b16 v[16:17], v6 offset:6144
    ds_read_b64_tr_b16 v[18:19], v6 offset:7168
    buffer_load_ushort v38, v12, s[16:19], s51 offen offset:64
    s_waitcnt lgkmcnt(8)
    v_mfma_f32_32x32x16_bf16 v[80:95], v[24:27], v[116:119], v[80:95]
    ds_read_b64_tr_b16 v[20:21], v7 offset:6144
    ds_read_b64_tr_b16 v[22:23], v7 offset:7168
    s_waitcnt lgkmcnt(8)
    v_mfma_f32_32x32x16_bf16 v[96:111], v[28:31], v[116:119], v[96:111]
    ds_read_b64_tr_b16 v[24:25], v6 offset:8192
    ds_read_b64_tr_b16 v[26:27], v6 offset:9216
    v_med3_f32 v34, v48, v10, v11
    v_mul_f32 v48, v34, v48
    s_waitcnt lgkmcnt(8)
    v_mfma_f32_32x32x16_bf16 v[80:95], v[40:43], v[120:123], v[80:95]
    ds_read_b64_tr_b16 v[28:29], v7 offset:8192
    ds_read_b64_tr_b16 v[30:31], v7 offset:9216
    v_med3_f32 v34, v49, v10, v11
    v_mul_f32 v49, v34, v49
    s_waitcnt lgkmcnt(8)
    v_mfma_f32_32x32x16_bf16 v[96:111], v[44:47], v[120:123], v[96:111]
    ds_read_b64_tr_b16 v[40:41], v6 offset:10240
    ds_read_b64_tr_b16 v[42:43], v6 offset:11264
    v_cvt_pk_bf16_f32 v48, v48, v49
    s_waitcnt lgkmcnt(8)
    v_mfma_f32_32x32x16_bf16 v[80:95], v[16:19], v[124:127], v[80:95]
    ds_read_b64_tr_b16 v[44:45], v7 offset:10240
    ds_read_b64_tr_b16 v[46:47], v7 offset:11264
    v_med3_f32 v34, v50, v10, v11
    v_mul_f32 v50, v34, v50
    s_waitcnt lgkmcnt(8)
    v_mfma_f32_32x32x16_bf16 v[96:111], v[20:23], v[124:127], v[96:111]
    ds_read_b64_tr_b16 v[16:17], v6 offset:12288
    ds_read_b64_tr_b16 v[18:19], v6 offset:13312
    v_med3_f32 v34, v51, v10, v11
    v_mul_f32 v51, v34, v51
    s_waitcnt lgkmcnt(8)
    v_mfma_f32_32x32x16_bf16 v[80:95], v[24:27], v[128:131], v[80:95]
    s_waitcnt vmcnt(10)
    s_mov_b64 exec, 1
    ds_add_u32 v15, v14
    s_mov_b64 exec, -1
    s_add_u32 s66, s66, 4
    ds_read_b64_tr_b16 v[20:21], v7 offset:12288
    ds_read_b64_tr_b16 v[22:23], v7 offset:13312
    v_cvt_pk_bf16_f32 v49, v50, v51
    s_waitcnt lgkmcnt(9)
    v_mfma_f32_32x32x16_bf16 v[96:111], v[28:31], v[128:131], v[96:111]
    ds_read_b64_tr_b16 v[24:25], v6 offset:14336
    ds_read_b64_tr_b16 v[26:27], v6 offset:15360
    s_waitcnt lgkmcnt(9)
    v_mfma_f32_32x32x16_bf16 v[80:95], v[40:43], v[132:135], v[80:95]
    ds_read_b64_tr_b16 v[28:29], v7 offset:14336
    ds_read_b64_tr_b16 v[30:31], v7 offset:15360
    v_med3_f32 v34, v52, v10, v11
    v_mul_f32 v52, v34, v52
    s_waitcnt lgkmcnt(9)
    v_mfma_f32_32x32x16_bf16 v[96:111], v[44:47], v[132:135], v[96:111]
    ds_read_b64_tr_b16 v[40:41], v6 offset:16384
    ds_read_b64_tr_b16 v[42:43], v6 offset:17408
    v_med3_f32 v34, v53, v10, v11
    v_mul_f32 v53, v34, v53
    s_waitcnt lgkmcnt(9)
    v_mfma_f32_32x32x16_bf16 v[80:95], v[16:19], v[136:139], v[80:95]
    ds_read_b64_tr_b16 v[44:45], v7 offset:16384
    ds_read_b64_tr_b16 v[46:47], v7 offset:17408
    v_cvt_pk_bf16_f32 v50, v52, v53
    s_waitcnt lgkmcnt(8)
    v_mfma_f32_32x32x16_bf16 v[96:111], v[20:23], v[136:139], v[96:111]
    ds_read_b32 v13, v15
    ds_read_b64_tr_b16 v[16:17], v6 offset:18432
    ds_read_b64_tr_b16 v[18:19], v6 offset:19456
    v_med3_f32 v34, v54, v10, v11
    v_mul_f32 v54, v34, v54
    s_waitcnt lgkmcnt(9)
    v_mfma_f32_32x32x16_bf16 v[80:95], v[24:27], v[140:143], v[80:95]
    ds_read_b64_tr_b16 v[20:21], v7 offset:18432
    ds_read_b64_tr_b16 v[22:23], v7 offset:19456
    v_med3_f32 v34, v55, v10, v11
    v_mul_f32 v55, v34, v55
    s_waitcnt lgkmcnt(9)
    v_mfma_f32_32x32x16_bf16 v[96:111], v[28:31], v[140:143], v[96:111]
    ds_read_b64_tr_b16 v[24:25], v6 offset:20480
    ds_read_b64_tr_b16 v[26:27], v6 offset:21504
    s_waitcnt lgkmcnt(9)
    v_mfma_f32_32x32x16_bf16 v[80:95], v[40:43], v[144:147], v[80:95]
    ds_read_b64_tr_b16 v[28:29], v7 offset:20480
    ds_read_b64_tr_b16 v[30:31], v7 offset:21504
    v_cvt_pk_bf16_f32 v51, v54, v55
    s_waitcnt lgkmcnt(9)
    v_mfma_f32_32x32x16_bf16 v[96:111], v[44:47], v[144:147], v[96:111]
    s_waitcnt lgkmcnt(8)
    v_readfirstlane_b32 s60, v13
    s_cmp_lt_u32 s60, s66
    s_cbranch_scc1 g1_poll10
g1_poll10_ret:
    ds_read_b64_tr_b16 v[40:41], v6 offset:22528
    ds_read_b64_tr_b16 v[42:43], v6 offset:23552
    s_add_u32 m0, s47, 0
    s_add_u32 s61, s45, s95
    v_med3_f32 v34, v56, v10, v11
    v_mul_f32 v56, v34, v56
    s_waitcnt lgkmcnt(8)
    v_mfma_f32_32x32x16_bf16 v[80:95], v[16:19], v[148:151], v[80:95]
    ds_read_b64_tr_b16 v[44:45], v7 offset:22528
    ds_read_b64_tr_b16 v[46:47], v7 offset:23552
    buffer_load_dwordx4 v2, s[8:11], s61 offen offset:0 lds
    v_med3_f32 v34, v57, v10, v11
    v_mul_f32 v57, v34, v57
    s_waitcnt lgkmcnt(8)
    v_mfma_f32_32x32x16_bf16 v[96:111], v[20:23], v[148:151], v[96:111]
    v_add_u32 v6, s46, v5
    v_xor_b32 v7, 64, v6
    s_add_u32 s46, s46, 24576
    s_cmp_ge_u32 s46, 98304
    s_cselect_b32 s46, 0, s46
    ds_read_b64_tr_b16 v[16:17], v6 offset:0
    ds_read_b64_tr_b16 v[18:19], v6 offset:1024
    buffer_load_dwordx4 v3, s[8:11], s61 offen offset:1024 lds
    v_cvt_pk_bf16_f32 v52, v56, v57
    s_waitcnt lgkmcnt(8)
    v_mfma_f32_32x32x16_bf16 v[80:95], v[24:27], v[152:155], v[80:95]
    ds_read_b64_tr_b16 v[20:21], v7 offset:0
    ds_read_b64_tr_b16 v[22:23], v7 offset:1024
    buffer_load_dwordx4 v4, s[8:11], s61 offen offset:2048 lds
    s_add_u32 m0, s47, 3072
    s_add_u32 s61, s61, s54
    v_med3_f32 v34, v58, v10, v11
    v_mul_f32 v58, v34, v58
    s_waitcnt lgkmcnt(8)
    v_mfma_f32_32x32x16_bf16 v[96:111], v[28:31], v[152:155], v[96:111]
    ds_read_b64_tr_b16 v[24:25], v6 offset:2048
    ds_read_b64_tr_b16 v[26:27], v6 offset:3072
    buffer_load_dwordx4 v2, s[8:11], s61 offen offset:0 lds
    s_waitcnt lgkmcnt(8)
    v_mfma_f32_32x32x16_bf16 v[80:95], v[40:43], v[156:159], v[80:95]
    ds_read_b64_tr_b16 v[28:29], v7 offset:2048
    ds_read_b64_tr_b16 v[30:31], v7 offset:3072
    buffer_load_dwordx4 v3, s[8:11], s61 offen offset:1024 lds
    v_med3_f32 v34, v59, v10, v11
    v_mul_f32 v59, v34, v59
    s_waitcnt lgkmcnt(8)
    v_mfma_f32_32x32x16_bf16 v[96:111], v[44:47], v[156:159], v[96:111]
    ds_read_b64_tr_b16 v[40:41], v6 offset:4096
    ds_read_b64_tr_b16 v[42:43], v6 offset:5120
    buffer_load_dwordx4 v4, s[8:11], s61 offen offset:2048 lds
    s_add_u32 s47, s47, 24576
    s_cmp_ge_u32 s47, 98304
    s_cselect_b32 s61, 98304, 0
    s_sub_u32 s47, s47, s61
    v_cvt_pk_bf16_f32 v53, v58, v59
    s_waitcnt lgkmcnt(8)
    v_mfma_f32_32x32x16_bf16 v[80:95], v[16:19], v[160:163], v[80:95]
    ds_read_b64_tr_b16 v[44:45], v7 offset:4096
    ds_read_b64_tr_b16 v[46:47], v7 offset:5120
    v_med3_f32 v34, v60, v10, v11
    v_mul_f32 v60, v34, v60
    s_waitcnt lgkmcnt(8)
    v_mfma_f32_32x32x16_bf16 v[96:111], v[20:23], v[160:163], v[96:111]
    ds_read_b64_tr_b16 v[16:17], v6 offset:6144
    ds_read_b64_tr_b16 v[18:19], v6 offset:7168
    v_med3_f32 v34, v61, v10, v11
    v_mul_f32 v61, v34, v61
    s_waitcnt lgkmcnt(8)
    v_mfma_f32_32x32x16_bf16 v[80:95], v[24:27], v[164:167], v[80:95]
    ds_read_b64_tr_b16 v[20:21], v7 offset:6144
    ds_read_b64_tr_b16 v[22:23], v7 offset:7168
    v_cvt_pk_bf16_f32 v54, v60, v61
    s_waitcnt lgkmcnt(8)
    v_mfma_f32_32x32x16_bf16 v[96:111], v[28:31], v[164:167], v[96:111]
    ds_read_b64_tr_b16 v[24:25], v6 offset:8192
    ds_read_b64_tr_b16 v[26:27], v6 offset:9216
    s_waitcnt lgkmcnt(8)
    v_mfma_f32_32x32x16_bf16 v[80:95], v[40:43], v[168:171], v[80:95]
    ds_read_b64_tr_b16 v[28:29], v7 offset:8192
    ds_read_b64_tr_b16 v[30:31], v7 offset:9216
    v_med3_f32 v34, v62, v10, v11
    v_mul_f32 v62, v34, v62
    s_waitcnt lgkmcnt(8)
    v_mfma_f32_32x32x16_bf16 v[96:111], v[44:47], v[168:171], v[96:111]
    ds_read_b64_tr_b16 v[40:41], v6 offset:10240
    ds_read_b64_tr_b16 v[42:43], v6 offset:11264
    v_med3_f32 v34, v63, v10, v11
    v_mul_f32 v63, v34, v63
    s_waitcnt lgkmcnt(8)
    v_mfma_f32_32x32x16_bf16 v[80:95], v[16:19], v[172:175], v[80:95]
    ds_read_b64_tr_b16 v[44:45], v7 offset:10240
    ds_read_b64_tr_b16 v[46:47], v7 offset:11264
    v_cvt_pk_bf16_f32 v55, v62, v63
    s_waitcnt lgkmcnt(8)
    v_mfma_f32_32x32x16_bf16 v[96:111], v[20:23], v[172:175], v[96:111]
    ds_read_b64_tr_b16 v[16:17], v6 offset:12288
    ds_read_b64_tr_b16 v[18:19], v6 offset:13312
    buffer_store_dwordx4 v[48:51], v9, s[12:15], s98 offen offset:0 sc1
    s_waitcnt lgkmcnt(8)
    v_mfma_f32_32x32x16_bf16 v[80:95], v[24:27], v[176:179], v[80:95]
    s_waitcnt vmcnt(9)
    s_mov_b64 exec, 1
    ds_add_u32 v15, v14
    s_mov_b64 exec, -1
    s_add_u32 s66, s66, 4
    ds_read_b64_tr_b16 v[20:21], v7 offset:12288
    ds_read_b64_tr_b16 v[22:23], v7 offset:13312
    buffer_store_dwordx4 v[52:55], v9, s[12:15], s98 offen offset:1024 sc1
    s_waitcnt lgkmcnt(9)
    v_mfma_f32_32x32x16_bf16 v[96:111], v[28:31], v[176:179], v[96:111]
    ds_read_b64_tr_b16 v[24:25], v6 offset:14336
    ds_read_b64_tr_b16 v[26:27], v6 offset:15360
    s_waitcnt lgkmcnt(9)
    v_mfma_f32_32x32x16_bf16 v[80:95], v[40:43], v[180:183], v[80:95]
    ds_read_b64_tr_b16 v[28:29], v7 offset:14336
    ds_read_b64_tr_b16 v[30:31], v7 offset:15360
    v_med3_f32 v34, v64, v10, v11
    v_mul_f32 v64, v34, v64
    s_waitcnt lgkmcnt(9)
    v_mfma_f32_32x32x16_bf16 v[96:111], v[44:47], v[180:183], v[96:111]
    ds_read_b64_tr_b16 v[40:41], v6 offset:16384
    ds_read_b64_tr_b16 v[42:43], v6 offset:17408
    v_med3_f32 v34, v65, v10, v11
    v_mul_f32 v65, v34, v65
    s_waitcnt lgkmcnt(9)
    v_mfma_f32_32x32x16_bf16 v[80:95], v[16:19], v[184:187], v[80:95]
    ds_read_b64_tr_b16 v[44:45], v7 offset:16384
    ds_read_b64_tr_b16 v[46:47], v7 offset:17408
    v_cvt_pk_bf16_f32 v64, v64, v65
    s_waitcnt lgkmcnt(8)
    v_mfma_f32_32x32x16_bf16 v[96:111], v[20:23], v[184:187], v[96:111]
    ds_read_b32 v13, v15
    ds_read_b64_tr_b16 v[16:17], v6 offset:18432
    ds_read_b64_tr_b16 v[18:19], v6 offset:19456
    v_med3_f32 v34, v66, v10, v11
    v_mul_f32 v66, v34, v66
    s_waitcnt lgkmcnt(9)
    v_mfma_f32_32x32x16_bf16 v[80:95], v[24:27], v[188:191], v[80:95]
    ds_read_b64_tr_b16 v[20:21], v7 offset:18432
    ds_read_b64_tr_b16 v[22:23], v7 offset:19456
    v_med3_f32 v34, v67, v10, v11
    v_mul_f32 v67, v34, v67
    s_waitcnt lgkmcnt(9)
    v_mfma_f32_32x32x16_bf16 v[96:111], v[28:31], v[188:191], v[96:111]
    ds_read_b64_tr_b16 v[24:25], v6 offset:20480
    ds_read_b64_tr_b16 v[26:27], v6 offset:21504
    v_cvt_pk_bf16_f32 v65, v66, v67
    s_waitcnt lgkmcnt(9)
    v_mfma_f32_32x32x16_bf16 v[80:95], v[40:43], v[192:195], v[80:95]
    ds_read_b64_tr_b16 v[28:29], v7 offset:20480
    ds_read_b64_tr_b16 v[30:31], v7 offset:21504
    s_waitcnt lgkmcnt(9)
    v_mfma_f32_32x32x16_bf16 v[96:111], v[44:47], v[192:195], v[96:111]
    s_waitcnt lgkmcnt(8)
    v_readfirstlane_b32 s60, v13
    s_cmp_lt_u32 s60, s66
    s_cbranch_scc1 g1_poll11
g1_poll11_ret:
    ds_read_b64_tr_b16 v[40:41], v6 offset:22528
    ds_read_b64_tr_b16 v[42:43], v6 offset:23552
    s_add_u32 m0, s47, 0
    s_add_u32 s61, s45, s96
    v_med3_f32 v34, v68, v10, v11
    v_mul_f32 v68, v34, v68
    s_waitcnt lgkmcnt(8)
    v_mfma_f32_32x32x16_bf16 v[80:95], v[16:19], v[196:199], v[80:95]
    ds_read_b64_tr_b16 v[44:45], v7 offset:22528
    ds_read_b64_tr_b16 v[46:47], v7 offset:23552
    buffer_load_dwordx4 v2, s[8:11], s61 offen offset:0 lds
    v_med3_f32 v34, v69, v10, v11
    v_mul_f32 v69, v34, v69
    s_waitcnt lgkmcnt(8)
    v_mfma_f32_32x32x16_bf16 v[96:111], v[20:23], v[196:199], v[96:111]
    v_add_u32 v6, s46, v5
    v_xor_b32 v7, 64, v6
    s_add_u32 s46, s46, 24576
    s_cmp_ge_u32 s46, 98304
    s_cselect_b32 s46, 0, s46
    ds_read_b64_tr_b16 v[16:17], v6 offset:0
    ds_read_b64_tr_b16 v[18:19], v6 offset:1024
    buffer_load_dwordx4 v3, s[8:11], s61 offen offset:1024 lds
    v_cvt_pk_bf16_f32 v66, v68, v69
    s_waitcnt lgkmcnt(8)
    v_mfma_f32_32x32x16_bf16 v[80:95], v[24:27], v[200:203], v[80:95]
    ds_read_b64_tr_b16 v[20:21], v7 offset:0
    ds_read_b64_tr_b16 v[22:23], v7 offset:1024
    buffer_load_dwordx4 v4, s[8:11], s61 offen offset:2048 lds
    s_add_u32 m0, s47, 3072
    s_add_u32 s61, s61, s54
    v_med3_f32 v34, v70, v10, v11
    v_mul_f32 v70, v34, v70
    s_waitcnt lgkmcnt(8)
    v_mfma_f32_32x32x16_bf16 v[96:111], v[28:31], v[200:203], v[96:111]
    ds_read_b64_tr_b16 v[24:25], v6 offset:2048
    ds_read_b64_tr_b16 v[26:27], v6 offset:3072
    buffer_load_dwordx4 v2, s[8:11], s61 offen offset:0 lds
    v_med3_f32 v34, v71, v10, v11
    v_mul_f32 v71, v34, v71
    s_waitcnt lgkmcnt(8)
    v_mfma_f32_32x32x16_bf16 v[80:95], v[40:43], v[204:207], v[80:95]
    ds_read_b64_tr_b16 v[28:29], v7 offset:2048
    ds_read_b64_tr_b16 v[30:31], v7 offset:3072
    buffer_load_dwordx4 v3, s[8:11], s61 offen offset:1024 lds
    s_waitcnt lgkmcnt(8)
    v_mfma_f32_32x32x16_bf16 v[96:111], v[44:47], v[204:207], v[96:111]
    ds_read_b64_tr_b16 v[40:41], v6 offset:4096
    ds_read_b64_tr_b16 v[42:43], v6 offset:5120
    buffer_load_dwordx4 v4, s[8:11], s61 offen offset:2048 lds
    s_add_u32 s47, s47, 24576
    s_cmp_ge_u32 s47, 98304
    s_cselect_b32 s61, 98304, 0
    s_sub_u32 s47, s47, s61
    v_cvt_pk_bf16_f32 v67, v70, v71
    s_waitcnt lgkmcnt(8)
    v_mfma_f32_32x32x16_bf16 v[80:95], v[16:19], v[208:211], v[80:95]
    ds_read_b64_tr_b16 v[44:45], v7 offset:4096
    ds_read_b64_tr_b16 v[46:47], v7 offset:5120
    v_med3_f32 v34, v72, v10, v11
    v_mul_f32 v72, v34, v72
    s_waitcnt lgkmcnt(8)
    v_mfma_f32_32x32x16_bf16 v[96:111], v[20:23], v[208:211], v[96:111]
    ds_read_b64_tr_b16 v[16:17], v6 offset:6144
    ds_read_b64_tr_b16 v[18:19], v6 offset:7168
    v_med3_f32 v34, v73, v10, v11
    v_mul_f32 v73, v34, v73
    s_waitcnt lgkmcnt(8)
    v_mfma_f32_32x32x16_bf16 v[80:95], v[24:27], v[212:215], v[80:95]
    ds_read_b64_tr_b16 v[20:21], v7 offset:6144
    ds_read_b64_tr_b16 v[22:23], v7 offset:7168
    v_cvt_pk_bf16_f32 v68, v72, v73
    s_waitcnt lgkmcnt(8)
    v_mfma_f32_32x32x16_bf16 v[96:111], v[28:31], v[212:215], v[96:111]
    ds_read_b64_tr_b16 v[24:25], v6 offset:8192
    ds_read_b64_tr_b16 v[26:27], v6 offset:9216
    v_med3_f32 v34, v74, v10, v11
    v_mul_f32 v74, v34, v74
    s_waitcnt lgkmcnt(8)
    v_mfma_f32_32x32x16_bf16 v[80:95], v[40:43], v[216:219], v[80:95]
    ds_read_b64_tr_b16 v[28:29], v7 offset:8192
    ds_read_b64_tr_b16 v[30:31], v7 offset:9216
    s_waitcnt lgkmcnt(8)
    v_mfma_f32_32x32x16_bf16 v[96:111], v[44:47], v[216:219], v[96:111]
    ds_read_b64_tr_b16 v[40:41], v6 offset:10240
    ds_read_b64_tr_b16 v[42:43], v6 offset:11264
    v_med3_f32 v34, v75, v10, v11
    v_mul_f32 v75, v34, v75
    s_waitcnt lgkmcnt(8)
    v_mfma_f32_32x32x16_bf16 v[80:95], v[16:19], v[220:223], v[80:95]
    ds_read_b64_tr_b16 v[44:45], v7 offset:10240
    ds_read_b64_tr_b16 v[46:47], v7 offset:11264
    v_cvt_pk_bf16_f32 v69, v74, v75
    s_waitcnt lgkmcnt(8)
    v_mfma_f32_32x32x16_bf16 v[96:111], v[20:23], v[220:223], v[96:111]
    ds_read_b64_tr_b16 v[16:17], v6 offset:12288
    ds_read_b64_tr_b16 v[18:19], v6 offset:13312
    v_med3_f32 v34, v76, v10, v11
    v_mul_f32 v76, v34, v76
    s_waitcnt lgkmcnt(8)
    v_mfma_f32_32x32x16_bf16 v[80:95], v[24:27], v[224:227], v[80:95]
    s_waitcnt vmcnt(8)
    s_mov_b64 exec, 1
    ds_add_u32 v15, v14
    s_mov_b64 exec, -1
    s_add_u32 s66, s66, 4
    ds_read_b64_tr_b16 v[20:21], v7 offset:12288
    ds_read_b64_tr_b16 v[22:23], v7 offset:13312
    v_med3_f32 v34, v77, v10, v11
    v_mul_f32 v77, v34, v77
    s_waitcnt lgkmcnt(9)
    v_mfma_f32_32x32x16_bf16 v[96:111], v[28:31], v[224:227], v[96:111]
    ds_read_b64_tr_b16 v[24:25], v6 offset:14336
    ds_read_b64_tr_b16 v[26:27], v6 offset:15360
    v_cvt_pk_bf16_f32 v70, v76, v77
    s_waitcnt lgkmcnt(9)
    v_mfma_f32_32x32x16_bf16 v[80:95], v[40:43], v[228:231], v[80:95]
    ds_read_b64_tr_b16 v[28:29], v7 offset:14336
    ds_read_b64_tr_b16 v[30:31], v7 offset:15360
    s_waitcnt lgkmcnt(9)
    v_mfma_f32_32x32x16_bf16 v[96:111], v[44:47], v[228:231], v[96:111]
    ds_read_b64_tr_b16 v[40:41], v6 offset:16384
    ds_read_b64_tr_b16 v[42:43], v6 offset:17408
    v_med3_f32 v34, v78, v10, v11
    v_mul_f32 v78, v34, v78
    s_waitcnt lgkmcnt(9)
    v_mfma_f32_32x32x16_bf16 v[80:95], v[16:19], v[232:235], v[80:95]
    ds_read_b64_tr_b16 v[44:45], v7 offset:16384
    ds_read_b64_tr_b16 v[46:47], v7 offset:17408
    v_med3_f32 v34, v79, v10, v11
    v_mul_f32 v79, v34, v79
    s_waitcnt lgkmcnt(8)
    v_mfma_f32_32x32x16_bf16 v[96:111], v[20:23], v[232:235], v[96:111]
    ds_read_b32 v13, v15
    ds_read_b64_tr_b16 v[16:17], v6 offset:18432
    ds_read_b64_tr_b16 v[18:19], v6 offset:19456
    v_cvt_pk_bf16_f32 v71, v78, v79
    s_waitcnt lgkmcnt(9)
    v_mfma_f32_32x32x16_bf16 v[80:95], v[24:27], v[236:239], v[80:95]
    ds_read_b64_tr_b16 v[20:21], v7 offset:18432
    ds_read_b64_tr_b16 v[22:23], v7 offset:19456
    buffer_store_dwordx4 v[64:67], v9, s[12:15], s98 offen offset:2048 sc1
    s_waitcnt lgkmcnt(9)
    v_mfma_f32_32x32x16_bf16 v[96:111], v[28:31], v[236:239], v[96:111]
    ds_read_b64_tr_b16 v[24:25], v6 offset:20480
    ds_read_b64_tr_b16 v[26:27], v6 offset:21504
    buffer_store_dwordx4 v[68:71], v9, s[12:15], s98 offen offset:3072 sc1
    s_waitcnt lgkmcnt(9)
    v_mfma_f32_32x32x16_bf16 v[80:95], v[40:43], v[240:243], v[80:95]
    ds_read_b64_tr_b16 v[28:29], v7 offset:20480
    ds_read_b64_tr_b16 v[30:31], v7 offset:21504
    s_waitcnt lgkmcnt(9)
    v_mfma_f32_32x32x16_bf16 v[96:111], v[44:47], v[240:243], v[96:111]
    s_waitcnt lgkmcnt(8)
    v_readfirstlane_b32 s60, v13
    s_cmp_lt_u32 s60, s66
    s_cbranch_scc1 g1_poll12
g1_poll12_ret:
    ds_read_b64_tr_b16 v[40:41], v6 offset:22528
    ds_read_b64_tr_b16 v[42:43], v6 offset:23552
    s_add_u32 m0, s47, 0
    s_add_u32 s61, s45, s97
    s_waitcnt lgkmcnt(8)
    v_mfma_f32_32x32x16_bf16 v[80:95], v[16:19], v[244:247], v[80:95]
    ds_read_b64_tr_b16 v[44:45], v7 offset:22528
    ds_read_b64_tr_b16 v[46:47], v7 offset:23552
    buffer_load_dwordx4 v2, s[8:11], s61 offen offset:0 lds
    s_waitcnt lgkmcnt(8)
    v_mfma_f32_32x32x16_bf16 v[96:111], v[20:23], v[244:247], v[96:111]
    v_add_u32 v6, s46, v5
    v_xor_b32 v7, 64, v6
    s_add_u32 s46, s46, 24576
    s_cmp_ge_u32 s46, 98304
    s_cselect_b32 s46, 0, s46
    ds_read_b64_tr_b16 v[16:17], v6 offset:0
    ds_read_b64_tr_b16 v[18:19], v6 offset:1024
    buffer_load_dwordx4 v3, s[8:11], s61 offen offset:1024 lds
    s_waitcnt lgkmcnt(8)
    v_mfma_f32_32x32x16_bf16 v[80:95], v[24:27], v[248:251], v[80:95]
    ds_read_b64_tr_b16 v[20:21], v7 offset:0
    ds_read_b64_tr_b16 v[22:23], v7 offset:1024
    buffer_load_dwordx4 v4, s[8:11], s61 offen offset:2048 lds
    s_add_u32 m0, s47, 3072
    s_add_u32 s61, s61, s54
    s_waitcnt lgkmcnt(8)
    v_mfma_f32_32x32x16_bf16 v[96:111], v[28:31], v[248:251], v[96:111]
    ds_read_b64_tr_b16 v[24:25], v6 offset:2048
    ds_read_b64_tr_b16 v[26:27], v6 offset:3072
    buffer_load_dwordx4 v2, s[8:11], s61 offen offset:0 lds
    s_waitcnt lgkmcnt(8)
    v_mfma_f32_32x32x16_bf16 v[80:95], v[40:43], v[252:255], v[80:95]
    ds_read_b64_tr_b16 v[28:29], v7 offset:2048
    ds_read_b64_tr_b16 v[30:31], v7 offset:3072
    buffer_load_dwordx4 v3, s[8:11], s61 offen offset:1024 lds
    s_waitcnt lgkmcnt(8)
    v_mfma_f32_32x32x16_bf16 v[96:111], v[44:47], v[252:255], v[96:111]
    ds_read_b64_tr_b16 v[40:41], v6 offset:4096
    ds_read_b64_tr_b16 v[42:43], v6 offset:5120
    buffer_load_dwordx4 v4, s[8:11], s61 offen offset:2048 lds
    s_add_u32 s47, s47, 24576
    s_cmp_ge_u32 s47, 98304
    s_cselect_b32 s61, 98304, 0
    s_sub_u32 s47, s47, s61
    s_mov_b32 s98, s50
    s_lshr_b32 s60, s51, 5
    s_add_u32 s60, s60, 36
    s_add_u32 s60, s60, s68
    s_lshl_b32 s50, s60, 10
    s_and_b32 s60, s48, 31
    s_lshl_b32 s60, s60, 7
    s_add_u32 s51, s60, s36
    s_lshr_b32 s48, s48, 5
    s_add_u32 s45, s37, s51
    s_add_u32 s44, s44, 1
    s_cmp_ge_u32 s44, s67
    s_cbranch_scc1 g1_end1
    s_branch g1_loop
g1_poll00:
    ds_read_b32 v13, v15
    s_waitcnt lgkmcnt(0)
    v_readfirstlane_b32 s60, v13
    s_cmp_lt_u32 s60, s66
    s_cbranch_scc1 g1_poll00
    s_branch g1_poll00_ret
g1_poll01:
    ds_read_b32 v13, v15
    s_waitcnt lgkmcnt(0)
    v_readfirstlane_b32 s60, v13
    s_cmp_lt_u32 s60, s66
    s_cbranch_scc1 g1_poll01
    s_branch g1_poll01_ret
g1_poll02:
    ds_read_b32 v13, v15
    s_waitcnt lgkmcnt(0)
    v_readfirstlane_b32 s60, v13
    s_cmp_lt_u32 s60, s66
    s_cbranch_scc1 g1_poll02
    s_branch g1_poll02_ret
g1_poll10:
    ds_read_b32 v13, v15
    s_waitcnt lgkmcnt(0)
    v_readfirstlane_b32 s60, v13
    s_cmp_lt_u32 s60, s66
    s_cbranch_scc1 g1_poll10
    s_branch g1_poll10_ret
g1_poll11:
    ds_read_b32 v13, v15
    s_waitcnt lgkmcnt(0)
    v_readfirstlane_b32 s60, v13
    s_cmp_lt_u32 s60, s66
    s_cbranch_scc1 g1_poll11
    s_branch g1_poll11_ret
g1_poll12:
    ds_read_b32 v13, v15
    s_waitcnt lgkmcnt(0)
    v_readfirstlane_b32 s60, v13
    s_cmp_lt_u32 s60, s66
    s_cbranch_scc1 g1_poll12
    s_branch g1_poll12_ret
g_ep0:
    s_nop 4
    s_cmp_eq_u32 s55, 2
    s_cbranch_scc1 g_epkv
    v_med3_f32 v34, v48, v10, v11
    v_mul_f32 v48, v34, v48
    v_med3_f32 v34, v49, v10, v11
    v_mul_f32 v49, v34, v49
    v_cvt_pk_bf16_f32 v48, v48, v49
    v_med3_f32 v34, v50, v10, v11
    v_mul_f32 v50, v34, v50
    v_med3_f32 v34, v51, v10, v11
    v_mul_f32 v51, v34, v51
    v_cvt_pk_bf16_f32 v49, v50, v51
    v_med3_f32 v34, v52, v10, v11
    v_mul_f32 v52, v34, v52
    v_med3_f32 v34, v53, v10, v11
    v_mul_f32 v53, v34, v53
    v_cvt_pk_bf16_f32 v50, v52, v53
    v_med3_f32 v34, v54, v10, v11
    v_mul_f32 v54, v34, v54
    v_med3_f32 v34, v55, v10, v11
    v_mul_f32 v55, v34, v55
    v_cvt_pk_bf16_f32 v51, v54, v55
    v_med3_f32 v34, v56, v10, v11
    v_mul_f32 v56, v34, v56
    v_med3_f32 v34, v57, v10, v11
    v_mul_f32 v57, v34, v57
    v_cvt_pk_bf16_f32 v52, v56, v57
    v_med3_f32 v34, v58, v10, v11
    v_mul_f32 v58, v34, v58
    v_med3_f32 v34, v59, v10, v11
    v_mul_f32 v59, v34, v59
    v_cvt_pk_bf16_f32 v53, v58, v59
    v_med3_f32 v34, v60, v10, v11
    v_mul_f32 v60, v34, v60
    v_med3_f32 v34, v61, v10, v11
    v_mul_f32 v61, v34, v61
    v_cvt_pk_bf16_f32 v54, v60, v61
    v_med3_f32 v34, v62, v10, v11
    v_mul_f32 v62, v34, v62
    v_med3_f32 v34, v63, v10, v11
    v_mul_f32 v63, v34, v63
    v_cvt_pk_bf16_f32 v55, v62, v63
    buffer_store_dwordx4 v[48:51], v9, s[12:15], s98 offen offset:0 sc1
    buffer_store_dwordx4 v[52:55], v9, s[12:15], s98 offen offset:1024 sc1
    v_med3_f32 v34, v64, v10, v11
    v_mul_f32 v64, v34, v64
    v_med3_f32 v34, v65, v10, v11
    v_mul_f32 v65, v34, v65
    v_cvt_pk_bf16_f32 v64, v64, v65
    v_med3_f32 v34, v66, v10, v11
    v_mul_f32 v66, v34, v66
    v_med3_f32 v34, v67, v10, v11
    v_mul_f32 v67, v34, v67
    v_cvt_pk_bf16_f32 v65, v66, v67
    v_med3_f32 v34, v68, v10, v11
    v_mul_f32 v68, v34, v68
    v_med3_f32 v34, v69, v10, v11
    v_mul_f32 v69, v34, v69
    v_cvt_pk_bf16_f32 v66, v68, v69
    v_med3_f32 v34, v70, v10, v11
    v_mul_f32 v70, v34, v70
    v_med3_f32 v34, v71, v10, v11
    v_mul_f32 v71, v34, v71
    v_cvt_pk_bf16_f32 v67, v70, v71
    v_med3_f32 v34, v72, v10, v11
    v_mul_f32 v72, v34, v72
    v_med3_f32 v34, v73, v10, v11
    v_mul_f32 v73, v34, v73
    v_cvt_pk_bf16_f32 v68, v72, v73
    v_med3_f32 v34, v74, v10, v11
    v_mul_f32 v74, v34, v74
    v_med3_f32 v34, v75, v10, v11
    v_mul_f32 v75, v34, v75
    v_cvt_pk_bf16_f32 v69, v74, v75
    v_med3_f32 v34, v76, v10, v11
    v_mul_f32 v76, v34, v76
    v_med3_f32 v34, v77, v10, v11
    v_mul_f32 v77, v34, v77
    v_cvt_pk_bf16_f32 v70, v76, v77
    v_med3_f32 v34, v78, v10, v11
    v_mul_f32 v78, v34, v78
    v_med3_f32 v34, v79, v10, v11
    v_mul_f32 v79, v34, v79
    v_cvt_pk_bf16_f32 v71, v78, v79
    buffer_store_dwordx4 v[64:67], v9, s[12:15], s98 offen offset:2048 sc1
    buffer_store_dwordx4 v[68:71], v9, s[12:15], s98 offen offset:3072 sc1
g_ep_done:
    s_mov_b32 s98, 2147418112
    v_mov_b32 v10, 0
    v_mov_b32 v11, 0x7f800000
    s_waitcnt vmcnt(0)
    s_mov_b64 exec, 1
    ds_add_u32 v15, v14 offset:12
    s_mov_b64 exec, -1
    s_waitcnt lgkmcnt(0)
    s_branch g_ep0_ret
g1_end1:
    s_nop 4
    v_med3_f32 v34, v80, v10, v11
    v_mul_f32 v80, v34, v80
    v_med3_f32 v34, v81, v10, v11
    v_mul_f32 v81, v34, v81
    v_cvt_pk_bf16_f32 v80, v80, v81
    v_med3_f32 v34, v82, v10, v11
    v_mul_f32 v82, v34, v82
    v_med3_f32 v34, v83, v10, v11
    v_mul_f32 v83, v34, v83
    v_cvt_pk_bf16_f32 v81, v82, v83
    v_med3_f32 v34, v84, v10, v11
    v_mul_f32 v84, v34, v84
    v_med3_f32 v34, v85, v10, v11
    v_mul_f32 v85, v34, v85
    v_cvt_pk_bf16_f32 v82, v84, v85
    v_med3_f32 v34, v86, v10, v11
    v_mul_f32 v86, v34, v86
    v_med3_f32 v34, v87, v10, v11
    v_mul_f32 v87, v34, v87
    v_cvt_pk_bf16_f32 v83, v86, v87
    v_med3_f32 v34, v88, v10, v11
    v_mul_f32 v88, v34, v88
    v_med3_f32 v34, v89, v10, v11
    v_mul_f32 v89, v34, v89
    v_cvt_pk_bf16_f32 v84, v88, v89
    v_med3_f32 v34, v90, v10, v11
    v_mul_f32 v90, v34, v90
    v_med3_f32 v34, v91, v10, v11
    v_mul_f32 v91, v34, v91
    v_cvt_pk_bf16_f32 v85, v90, v91
    v_med3_f32 v34, v92, v10, v11
    v_mul_f32 v92, v34, v92
    v_med3_f32 v34, v93, v10, v11
    v_mul_f32 v93, v34, v93
    v_cvt_pk_bf16_f32 v86, v92, v93
    v_med3_f32 v34, v94, v10, v11
    v_mul_f32 v94, v34, v94
    v_med3_f32 v34, v95, v10, v11
    v_mul_f32 v95, v34, v95
    v_cvt_pk_bf16_f32 v87, v94, v95
    buffer_store_dwordx4 v[80:83], v9, s[12:15], s98 offen offset:0 sc1
    buffer_store_dwordx4 v[84:87], v9, s[12:15], s98 offen offset:1024 sc1
    v_med3_f32 v34, v96, v10, v11
    v_mul_f32 v96, v34, v96
    v_med3_f32 v34, v97, v10, v11
    v_mul_f32 v97, v34, v97
    v_cvt_pk_bf16_f32 v96, v96, v97
    v_med3_f32 v34, v98, v10, v11
    v_mul_f32 v98, v34, v98
    v_med3_f32 v34, v99, v10, v11
    v_mul_f32 v99, v34, v99
    v_cvt_pk_bf16_f32 v97, v98, v99
    v_med3_f32 v34, v100, v10, v11
    v_mul_f32 v100, v34, v100
    v_med3_f32 v34, v101, v10, v11
    v_mul_f32 v101, v34, v101
    v_cvt_pk_bf16_f32 v98, v100, v101
    v_med3_f32 v34, v102, v10, v11
    v_mul_f32 v102, v34, v102
    v_med3_f32 v34, v103, v10, v11
    v_mul_f32 v103, v34, v103
    v_cvt_pk_bf16_f32 v99, v102, v103
    v_med3_f32 v34, v104, v10, v11
    v_mul_f32 v104, v34, v104
    v_med3_f32 v34, v105, v10, v11
    v_mul_f32 v105, v34, v105
    v_cvt_pk_bf16_f32 v100, v104, v105
    v_med3_f32 v34, v106, v10, v11
    v_mul_f32 v106, v34, v106
    v_med3_f32 v34, v107, v10, v11
    v_mul_f32 v107, v34, v107
    v_cvt_pk_bf16_f32 v101, v106, v107
    v_med3_f32 v34, v108, v10, v11
    v_mul_f32 v108, v34, v108
    v_med3_f32 v34, v109, v10, v11
    v_mul_f32 v109, v34, v109
    v_cvt_pk_bf16_f32 v102, v108, v109
    v_med3_f32 v34, v110, v10, v11
    v_mul_f32 v110, v34, v110
    v_med3_f32 v34, v111, v10, v11
    v_mul_f32 v111, v34, v111
    v_cvt_pk_bf16_f32 v103, v110, v111
    buffer_store_dwordx4 v[96:99], v9, s[12:15], s98 offen offset:2048 sc1
    buffer_store_dwordx4 v[100:103], v9, s[12:15], s98 offen offset:3072 sc1
    s_branch g1_done
g1_end0:
    s_nop 4
    v_med3_f32 v34, v48, v10, v11
    v_mul_f32 v48, v34, v48
    v_med3_f32 v34, v49, v10, v11
    v_mul_f32 v49, v34, v49
    v_cvt_pk_bf16_f32 v48, v48, v49
    v_med3_f32 v34, v50, v10, v11
    v_mul_f32 v50, v34, v50
    v_med3_f32 v34, v51, v10, v11
    v_mul_f32 v51, v34, v51
    v_cvt_pk_bf16_f32 v49, v50, v51
    v_med3_f32 v34, v52, v10, v11
    v_mul_f32 v52, v34, v52
    v_med3_f32 v34, v53, v10, v11
    v_mul_f32 v53, v34, v53
    v_cvt_pk_bf16_f32 v50, v52, v53
    v_med3_f32 v34, v54, v10, v11
    v_mul_f32 v54, v34, v54
    v_med3_f32 v34, v55, v10, v11
    v_mul_f32 v55, v34, v55
    v_cvt_pk_bf16_f32 v51, v54, v55
    v_med3_f32 v34, v56, v10, v11
    v_mul_f32 v56, v34, v56
    v_med3_f32 v34, v57, v10, v11
    v_mul_f32 v57, v34, v57
    v_cvt_pk_bf16_f32 v52, v56, v57
    v_med3_f32 v34, v58, v10, v11
    v_mul_f32 v58, v34, v58
    v_med3_f32 v34, v59, v10, v11
    v_mul_f32 v59, v34, v59
    v_cvt_pk_bf16_f32 v53, v58, v59
    v_med3_f32 v34, v60, v10, v11
    v_mul_f32 v60, v34, v60
    v_med3_f32 v34, v61, v10, v11
    v_mul_f32 v61, v34, v61
    v_cvt_pk_bf16_f32 v54, v60, v61
    v_med3_f32 v34, v62, v10, v11
    v_mul_f32 v62, v34, v62
    v_med3_f32 v34, v63, v10, v11
    v_mul_f32 v63, v34, v63
    v_cvt_pk_bf16_f32 v55, v62, v63
    buffer_store_dwordx4 v[48:51], v9, s[12:15], s98 offen offset:0 sc1
    buffer_store_dwordx4 v[52:55], v9, s[12:15], s98 offen offset:1024 sc1
    v_med3_f32 v34, v64, v10, v11
    v_mul_f32 v64, v34, v64
    v_med3_f32 v34, v65, v10, v11
    v_mul_f32 v65, v34, v65
    v_cvt_pk_bf16_f32 v64, v64, v65
    v_med3_f32 v34, v66, v10, v11
    v_mul_f32 v66, v34, v66
    v_med3_f32 v34, v67, v10, v11
    v_mul_f32 v67, v34, v67
    v_cvt_pk_bf16_f32 v65, v66, v67
    v_med3_f32 v34, v68, v10, v11
    v_mul_f32 v68, v34, v68
    v_med3_f32 v34, v69, v10, v11
    v_mul_f32 v69, v34, v69
    v_cvt_pk_bf16_f32 v66, v68, v69
    v_med3_f32 v34, v70, v10, v11
    v_mul_f32 v70, v34, v70
    v_med3_f32 v34, v71, v10, v11
    v_mul_f32 v71, v34, v71
    v_cvt_pk_bf16_f32 v67, v70, v71
    v_med3_f32 v34, v72, v10, v11
    v_mul_f32 v72, v34, v72
    v_med3_f32 v34, v73, v10, v11
    v_mul_f32 v73, v34, v73
    v_cvt_pk_bf16_f32 v68, v72, v73
    v_med3_f32 v34, v74, v10, v11
    v_mul_f32 v74, v34, v74
    v_med3_f32 v34, v75, v10, v11
    v_mul_f32 v75, v34, v75
    v_cvt_pk_bf16_f32 v69, v74, v75
    v_med3_f32 v34, v76, v10, v11
    v_mul_f32 v76, v34, v76
    v_med3_f32 v34, v77, v10, v11
    v_mul_f32 v77, v34, v77
    v_cvt_pk_bf16_f32 v70, v76, v77
    v_med3_f32 v34, v78, v10, v11
    v_mul_f32 v78, v34, v78
    v_med3_f32 v34, v79, v10, v11
    v_mul_f32 v79, v34, v79
    v_cvt_pk_bf16_f32 v71, v78, v79
    buffer_store_dwordx4 v[64:67], v9, s[12:15], s98 offen offset:2048 sc1
    buffer_store_dwordx4 v[68:71], v9, s[12:15], s98 offen offset:3072 sc1
g1_done:
    s_cmp_eq_u32 s46, 0
    s_cselect_b32 s46, 98304, s46
    s_sub_u32 s46, s46, 24576
    s_and_b32 s48, s59, 1
    s_lshl_b32 s48, s48, 6
    s_add_u32 s48, s48, 1024
    s_waitcnt vmcnt(0) lgkmcnt(0)
    v_mov_b32 v32, 0
    v_mov_b32 v33, 0
    v_mov_b32 v34, 0
    v_mov_b32 v35, 0
    v_mov_b32 v36, 0
    v_mov_b32 v37, 0
    v_mov_b32 v38, 0
    v_mov_b32 v39, 0
    v_mov_b32 v40, 0
    v_mov_b32 v41, 0
    v_mov_b32 v42, 0
    v_mov_b32 v43, 0
    v_mov_b32 v44, 0
    v_mov_b32 v45, 0
    v_mov_b32 v46, 0
    v_mov_b32 v47, 0
    v_mov_b32 v48, 0
    v_mov_b32 v49, 0
    v_mov_b32 v50, 0
    v_mov_b32 v51, 0
    v_mov_b32 v52, 0
    v_mov_b32 v53, 0
    v_mov_b32 v54, 0
    v_mov_b32 v55, 0
    v_mov_b32 v56, 0
    v_mov_b32 v57, 0
    v_mov_b32 v58, 0
    v_mov_b32 v59, 0
    v_mov_b32 v60, 0
    v_mov_b32 v61, 0
    v_mov_b32 v62, 0
    v_mov_b32 v63, 0
    v_mov_b32 v64, 0
    v_mov_b32 v65, 0
    v_mov_b32 v66, 0
    v_mov_b32 v67, 0
    v_mov_b32 v68, 0
    v_mov_b32 v69, 0
    v_mov_b32 v70, 0
    v_mov_b32 v71, 0
    v_mov_b32 v72, 0
    v_mov_b32 v73, 0
    v_mov_b32 v74, 0
    v_mov_b32 v75, 0
    v_mov_b32 v76, 0
    v_mov_b32 v77, 0
    v_mov_b32 v78, 0
    v_mov_b32 v79, 0
    v_mov_b32 v80, 0
    v_mov_b32 v81, 0
    v_mov_b32 v82, 0
    v_mov_b32 v83, 0
    v_mov_b32 v84, 0
    v_mov_b32 v85, 0
    v_mov_b32 v86, 0
    v_mov_b32 v87, 0
    v_mov_b32 v88, 0
    v_mov_b32 v89, 0
    v_mov_b32 v90, 0
    v_mov_b32 v91, 0
    v_mov_b32 v92, 0
    v_mov_b32 v93, 0
    v_mov_b32 v94, 0
    v_mov_b32 v95, 0
    v_mov_b32 v96, 0
    v_mov_b32 v97, 0
    v_mov_b32 v98, 0
    v_mov_b32 v99, 0
    v_mov_b32 v100, 0
    v_mov_b32 v101, 0
    v_mov_b32 v102, 0
    v_mov_b32 v103, 0
    v_mov_b32 v104, 0
    v_mov_b32 v105, 0
    v_mov_b32 v106, 0
    v_mov_b32 v107, 0
    v_mov_b32 v108, 0
    v_mov_b32 v109, 0
    v_mov_b32 v110, 0
    v_mov_b32 v111, 0
    s_mov_b64 exec, 1
    ds_add_rtn_u32 v13, v15, v14 offset:8
    s_mov_b64 exec, -1
    s_waitcnt lgkmcnt(0)
    v_readfirstlane_b32 s60, v13
    s_mov_b32 s65, 0
    s_lshl_b32 s64, s42, 4
    s_add_u32 s64, s64, s41
    s_lshl_b32 s64, s64, 7
    s_add_u32 s64, s64, 22609984
    s_mov_b32 s61, s60
g_hr:
    ds_read_b32 v13, v15 offset:4
    s_waitcnt lgkmcnt(0)
    v_readfirstlane_b32 s60, v13
    s_cmp_eq_u32 s60, 0
    s_cbranch_scc1 g_hr
    s_cmp_lg_u32 s61, 3
    s_cbranch_scc1 g_hw
    s_mul_i32 s60, s59, 124
    s_sub_u32 s60, s64, s60
    v_lshlrev_b32 v29, 7, v1
    s_mov_b64 exec, 15
    buffer_store_dword v14, v29, s[12:15], s60 offen sc1
    s_mov_b64 exec, -1
g_hw:
    s_mul_i32 s61, s38, 72
    s_add_u32 s60, s68, s61
    s_add_u32 s60, s60, 36
    s_lshl_b32 s69, s60, 10
    s_and_b32 s60, s101, 15
    s_mul_i32 s60, s60, 12288
    s_add_u32 s52, s69, s60
    buffer_load_dwordx4 v[112:115], v9, s[12:15], s52 offen offset:0 sc1
    buffer_load_dwordx4 v[116:119], v9, s[12:15], s52 offen offset:1024 sc1
    buffer_load_dwordx4 v[120:123], v9, s[12:15], s52 offen offset:2048 sc1
    buffer_load_dwordx4 v[124:127], v9, s[12:15], s52 offen offset:3072 sc1
    s_add_u32 s52, s52, 4096
    buffer_load_dwordx4 v[128:131], v9, s[12:15], s52 offen offset:0 sc1
    buffer_load_dwordx4 v[132:135], v9, s[12:15], s52 offen offset:1024 sc1
    buffer_load_dwordx4 v[136:139], v9, s[12:15], s52 offen offset:2048 sc1
    buffer_load_dwordx4 v[140:143], v9, s[12:15], s52 offen offset:3072 sc1
    s_add_u32 s52, s52, 4096
    buffer_load_dwordx4 v[144:147], v9, s[12:15], s52 offen offset:0 sc1
    buffer_load_dwordx4 v[148:151], v9, s[12:15], s52 offen offset:1024 sc1
    buffer_load_dwordx4 v[152:155], v9, s[12:15], s52 offen offset:2048 sc1
    buffer_load_dwordx4 v[156:159], v9, s[12:15], s52 offen offset:3072 sc1
    s_add_u32 s52, s52, 4096
    s_mul_i32 s60, s38, 2359296
    s_mul_i32 s61, s43, 36864
    s_add_u32 s60, s60, s61
    s_add_u32 s63, s60, 26214400
    s_mov_b32 s44, 0
    s_waitcnt lgkmcnt(0)
    s_mov_b64 exec, 1
    ds_add_u32 v15, v14
    s_mov_b64 exec, -1
    s_add_u32 s66, s66, 4
    v_add_u32 v6, s46, v5
    v_xor_b32 v7, 64, v6
    s_add_u32 s46, s46, 24576
    s_cmp_ge_u32 s46, 98304
    s_cselect_b32 s46, 0, s46
g_pg2first:
    ds_read_b32 v13, v15
    s_waitcnt lgkmcnt(0)
    v_readfirstlane_b32 s60, v13
    s_cmp_ge_u32 s60, s66
    s_cbranch_scc0 g_pg2first
    ds_read_b64_tr_b16 v[16:17], v6 offset:0
    ds_read_b64_tr_b16 v[18:19], v6 offset:1024
    ds_read_b64_tr_b16 v[20:21], v7 offset:0
    ds_read_b64_tr_b16 v[22:23], v7 offset:1024
    ds_read_b64_tr_b16 v[24:25], v6 offset:2048
    ds_read_b64_tr_b16 v[26:27], v6 offset:3072
    ds_read_b64_tr_b16 v[28:29], v7 offset:2048
    ds_read_b64_tr_b16 v[30:31], v7 offset:3072
    ds_read_b64_tr_b16 v[160:161], v6 offset:4096
    ds_read_b64_tr_b16 v[162:163], v6 offset:5120
    s_setprio 0
g2_loop:
    s_and_b32 s61, s101, 15
    s_lshr_b32 s101, s101, 4
    s_and_b32 s60, s101, 15
    s_mul_i32 s60, s60, 12288
    s_add_u32 s52, s69, s60
    s_cmp_eq_u32 s44, 5
    s_cselect_b32 s52, 2147418112, s52
    s_bitcmp1_b32 s58, s61
    s_cbranch_scc0 g2_ab
    s_waitcnt vmcnt(11) lgkmcnt(8)
    v_mfma_f32_32x32x16_bf16 v[48:63], v[16:19], v[112:115], v[48:63]
    ds_read_b64_tr_b16 v[164:165], v7 offset:4096
    ds_read_b64_tr_b16 v[166:167], v7 offset:5120
    s_waitcnt lgkmcnt(8)
    v_mfma_f32_32x32x16_bf16 v[64:79], v[20:23], v[112:115], v[64:79]
    ds_read_b64_tr_b16 v[16:17], v6 offset:6144
    ds_read_b64_tr_b16 v[18:19], v6 offset:7168
    s_waitcnt vmcnt(10) lgkmcnt(8)
    v_mfma_f32_32x32x16_bf16 v[48:63], v[24:27], v[116:119], v[48:63]
    ds_read_b64_tr_b16 v[20:21], v7 offset:6144
    ds_read_b64_tr_b16 v[22:23], v7 offset:7168
    s_waitcnt lgkmcnt(8)
    v_mfma_f32_32x32x16_bf16 v[64:79], v[28:31], v[116:119], v[64:79]
    ds_read_b64_tr_b16 v[24:25], v6 offset:8192
    ds_read_b64_tr_b16 v[26:27], v6 offset:9216
    s_waitcnt vmcnt(9) lgkmcnt(8)
    v_mfma_f32_32x32x16_bf16 v[48:63], v[160:163], v[120:123], v[48:63]
    ds_read_b64_tr_b16 v[28:29], v7 offset:8192
    ds_read_b64_tr_b16 v[30:31], v7 offset:9216
    s_waitcnt lgkmcnt(8)
    v_mfma_f32_32x32x16_bf16 v[64:79], v[164:167], v[120:123], v[64:79]
    ds_read_b64_tr_b16 v[160:161], v6 offset:10240
    ds_read_b64_tr_b16 v[162:163], v6 offset:11264
    s_waitcnt vmcnt(8) lgkmcnt(8)
    v_mfma_f32_32x32x16_bf16 v[48:63], v[16:19], v[124:127], v[48:63]
    ds_read_b64_tr_b16 v[164:165], v7 offset:10240
    ds_read_b64_tr_b16 v[166:167], v7 offset:11264
    s_waitcnt lgkmcnt(8)
    v_mfma_f32_32x32x16_bf16 v[64:79], v[20:23], v[124:127], v[64:79]
    ds_read_b64_tr_b16 v[16:17], v6 offset:12288
    ds_read_b64_tr_b16 v[18:19], v6 offset:13312
    s_waitcnt vmcnt(7) lgkmcnt(8)
    v_mfma_f32_32x32x16_bf16 v[48:63], v[24:27], v[128:131], v[48:63]
    s_waitcnt vmcnt(63)
    s_mov_b64 exec, 1
    ds_add_u32 v15, v14
    s_mov_b64 exec, -1
    s_add_u32 s66, s66, 4
    ds_read_b64_tr_b16 v[20:21], v7 offset:12288
    ds_read_b64_tr_b16 v[22:23], v7 offset:13312
    s_waitcnt lgkmcnt(9)
    v_mfma_f32_32x32x16_bf16 v[64:79], v[28:31], v[128:131], v[64:79]
    ds_read_b64_tr_b16 v[24:25], v6 offset:14336
    ds_read_b64_tr_b16 v[26:27], v6 offset:15360
    s_waitcnt vmcnt(6) lgkmcnt(9)
    v_mfma_f32_32x32x16_bf16 v[48:63], v[160:163], v[132:135], v[48:63]
    ds_read_b64_tr_b16 v[28:29], v7 offset:14336
    ds_read_b64_tr_b16 v[30:31], v7 offset:15360
    s_waitcnt lgkmcnt(9)
    v_mfma_f32_32x32x16_bf16 v[64:79], v[164:167], v[132:135], v[64:79]
    ds_read_b64_tr_b16 v[160:161], v6 offset:16384
    ds_read_b64_tr_b16 v[162:163], v6 offset:17408
    s_waitcnt vmcnt(5) lgkmcnt(9)
    v_mfma_f32_32x32x16_bf16 v[48:63], v[16:19], v[136:139], v[48:63]
    ds_read_b64_tr_b16 v[164:165], v7 offset:16384
    ds_read_b64_tr_b16 v[166:167], v7 offset:17408
    s_waitcnt lgkmcnt(8)
    v_mfma_f32_32x32x16_bf16 v[64:79], v[20:23], v[136:139], v[64:79]
    ds_read_b32 v13, v15
    ds_read_b64_tr_b16 v[16:17], v6 offset:18432
    ds_read_b64_tr_b16 v[18:19], v6 offset:19456
    s_waitcnt vmcnt(4) lgkmcnt(9)
    v_mfma_f32_32x32x16_bf16 v[48:63], v[24:27], v[140:143], v[48:63]
    ds_read_b64_tr_b16 v[20:21], v7 offset:18432
    ds_read_b64_tr_b16 v[22:23], v7 offset:19456
    s_waitcnt lgkmcnt(9)
    v_mfma_f32_32x32x16_bf16 v[64:79], v[28:31], v[140:143], v[64:79]
    ds_read_b64_tr_b16 v[24:25], v6 offset:20480
    ds_read_b64_tr_b16 v[26:27], v6 offset:21504
    s_waitcnt vmcnt(3) lgkmcnt(9)
    v_mfma_f32_32x32x16_bf16 v[48:63], v[160:163], v[144:147], v[48:63]
    ds_read_b64_tr_b16 v[28:29], v7 offset:20480
    ds_read_b64_tr_b16 v[30:31], v7 offset:21504
    s_waitcnt lgkmcnt(9)
    v_mfma_f32_32x32x16_bf16 v[64:79], v[164:167], v[144:147], v[64:79]
    s_waitcnt lgkmcnt(8)
    v_readfirstlane_b32 s60, v13
    s_cmp_lt_u32 s60, s66
    s_cbranch_scc1 g2_pollASBA
g2_pollASBA_ret:
    ds_read_b64_tr_b16 v[160:161], v6 offset:22528
    ds_read_b64_tr_b16 v[162:163], v6 offset:23552
    s_add_u32 s62, s89, 128
    s_cmp_eq_u32 s87, 0
    s_cselect_b32 s62, s89, s62
    s_cmp_eq_u32 s87, 1
    s_cselect_b32 s62, s48, s62
    s_add_u32 s62, s62, s86
    s_waitcnt vmcnt(2) lgkmcnt(8)
    v_mfma_f32_32x32x16_bf16 v[48:63], v[16:19], v[148:151], v[48:63]
    ds_read_b64_tr_b16 v[164:165], v7 offset:22528
    ds_read_b64_tr_b16 v[166:167], v7 offset:23552
    s_add_u32 m0, s47, 0
    s_add_u32 s61, s62, 0
    buffer_load_dwordx4 v2, s[8:11], s61 offen offset:0 lds
    s_waitcnt lgkmcnt(8)
    v_mfma_f32_32x32x16_bf16 v[64:79], v[20:23], v[148:151], v[64:79]
    v_add_u32 v6, s46, v5
    v_xor_b32 v7, 64, v6
    s_add_u32 s46, s46, 24576
    s_cmp_ge_u32 s46, 98304
    s_cselect_b32 s46, 0, s46
    ds_read_b64_tr_b16 v[16:17], v6 offset:0
    ds_read_b64_tr_b16 v[18:19], v6 offset:1024
    buffer_load_dwordx4 v3, s[8:11], s61 offen offset:1024 lds
    buffer_load_dwordx4 v4, s[8:11], s61 offen offset:2048 lds
    s_waitcnt vmcnt(4) lgkmcnt(8)
    v_mfma_f32_32x32x16_bf16 v[48:63], v[24:27], v[152:155], v[48:63]
    ds_read_b64_tr_b16 v[20:21], v6 offset:2048
    ds_read_b64_tr_b16 v[22:23], v6 offset:3072
    s_add_u32 m0, s47, 3072
    s_add_u32 s61, s62, 27648
    buffer_load_dwordx4 v2, s[8:11], s61 offen offset:0 lds
    buffer_load_dwordx4 v3, s[8:11], s61 offen offset:1024 lds
    s_waitcnt lgkmcnt(8)
    v_mfma_f32_32x32x16_bf16 v[64:79], v[28:31], v[152:155], v[64:79]
    ds_read_b64_tr_b16 v[24:25], v6 offset:4096
    ds_read_b64_tr_b16 v[26:27], v6 offset:5120
    buffer_load_dwordx4 v4, s[8:11], s61 offen offset:2048 lds
    s_add_u32 s47, s47, 24576
    s_cmp_ge_u32 s47, 98304
    s_cselect_b32 s61, 98304, 0
    s_sub_u32 s47, s47, s61
    s_waitcnt vmcnt(6) lgkmcnt(8)
    v_mfma_f32_32x32x16_bf16 v[48:63], v[160:163], v[156:159], v[48:63]
    ds_read_b64_tr_b16 v[28:29], v6 offset:6144
    ds_read_b64_tr_b16 v[30:31], v6 offset:7168
    s_and_b32 s62, s100, 15
    s_bitcmp1_b32 s58, s62
    s_cselect_b32 s62, 1, 2
    s_cmp_eq_u32 s87, 0
    s_cselect_b32 s62, s62, 2
    s_waitcnt lgkmcnt(8)
    v_mfma_f32_32x32x16_bf16 v[64:79], v[164:167], v[156:159], v[64:79]
    ds_read_b64_tr_b16 v[160:161], v6 offset:8192
    ds_read_b64_tr_b16 v[162:163], v6 offset:9216
    s_cmp_eq_u32 s87, 2
    s_cselect_b32 s87, 0, s62
    s_cselect_b32 s62, 4, 0
    s_addc_u32 s88, s88, 0
    s_lshr_b32 s100, s100, s62
    s_and_b32 s62, s100, 15
    s_mul_i32 s62, s62, 221184
    s_add_u32 s86, s56, s62
    s_cmp_ge_u32 s88, 6
    s_cselect_b32 s86, 2147418112, s86
    s_waitcnt lgkmcnt(8)
    v_mfma_f32_32x32x16_bf16 v[32:47], v[16:19], v[112:115], v[32:47]
    ds_read_b64_tr_b16 v[164:165], v6 offset:10240
    ds_read_b64_tr_b16 v[166:167], v6 offset:11264
    s_waitcnt lgkmcnt(8)
    v_mfma_f32_32x32x16_bf16 v[32:47], v[20:23], v[116:119], v[32:47]
    s_waitcnt vmcnt(63)
    s_mov_b64 exec, 1
    ds_add_u32 v15, v14
    s_mov_b64 exec, -1
    s_add_u32 s66, s66, 4
    ds_read_b64_tr_b16 v[16:17], v6 offset:12288
    ds_read_b64_tr_b16 v[18:19], v6 offset:13312
    s_waitcnt lgkmcnt(9)
    v_mfma_f32_32x32x16_bf16 v[32:47], v[24:27], v[120:123], v[32:47]
    ds_read_b64_tr_b16 v[20:21], v6 offset:14336
    ds_read_b64_tr_b16 v[22:23], v6 offset:15360
    s_waitcnt lgkmcnt(9)
    v_mfma_f32_32x32x16_bf16 v[32:47], v[28:31], v[124:127], v[32:47]
    ds_read_b32 v13, v15
    ds_read_b64_tr_b16 v[24:25], v6 offset:16384
    ds_read_b64_tr_b16 v[26:27], v6 offset:17408
    s_waitcnt lgkmcnt(10)
    v_mfma_f32_32x32x16_bf16 v[32:47], v[160:163], v[128:131], v[32:47]
    ds_read_b64_tr_b16 v[28:29], v6 offset:18432
    ds_read_b64_tr_b16 v[30:31], v6 offset:19456
    s_waitcnt lgkmcnt(10)
    v_mfma_f32_32x32x16_bf16 v[32:47], v[164:167], v[132:135], v[32:47]
    ds_read_b64_tr_b16 v[160:161], v6 offset:20480
    ds_read_b64_tr_b16 v[162:163], v6 offset:21504
    s_waitcnt lgkmcnt(9)
    v_mfma_f32_32x32x16_bf16 v[32:47], v[16:19], v[136:139], v[32:47]
    s_waitcnt lgkmcnt(6)
    v_readfirstlane_b32 s60, v13
    s_cmp_lt_u32 s60, s66
    s_cbranch_scc1 g2_pollASBS
g2_pollASBS_ret:
    ds_read_b64_tr_b16 v[164:165], v6 offset:22528
    ds_read_b64_tr_b16 v[166:167], v6 offset:23552
    s_add_u32 s62, s89, 128
    s_cmp_eq_u32 s87, 0
    s_cselect_b32 s62, s89, s62
    s_cmp_eq_u32 s87, 1
    s_cselect_b32 s62, s48, s62
    s_add_u32 s62, s62, s86
    v_mfma_f32_32x32x16_bf16 v[32:47], v[20:23], v[140:143], v[32:47]
    v_add_u32 v6, s46, v5
    v_xor_b32 v7, 64, v6
    s_add_u32 s46, s46, 24576
    s_cmp_ge_u32 s46, 98304
    s_cselect_b32 s46, 0, s46
    ds_read_b64_tr_b16 v[16:17], v6 offset:0
    ds_read_b64_tr_b16 v[18:19], v6 offset:1024
    s_add_u32 m0, s47, 0
    s_add_u32 s61, s62, 0
    buffer_load_dwordx4 v2, s[8:11], s61 offen offset:0 lds
    buffer_load_dwordx4 v3, s[8:11], s61 offen offset:1024 lds
    s_waitcnt lgkmcnt(8)
    v_mfma_f32_32x32x16_bf16 v[32:47], v[24:27], v[144:147], v[32:47]
    ds_read_b64_tr_b16 v[20:21], v7 offset:0
    ds_read_b64_tr_b16 v[22:23], v7 offset:1024
    buffer_load_dwordx4 v4, s[8:11], s61 offen offset:2048 lds
    s_add_u32 m0, s47, 3072
    s_add_u32 s61, s62, 27648
    buffer_load_dwordx4 v2, s[8:11], s61 offen offset:0 lds
    s_waitcnt lgkmcnt(8)
    v_mfma_f32_32x32x16_bf16 v[32:47], v[28:31], v[148:151], v[32:47]
    ds_read_b64_tr_b16 v[24:25], v6 offset:2048
    ds_read_b64_tr_b16 v[26:27], v6 offset:3072
    buffer_load_dwordx4 v3, s[8:11], s61 offen offset:1024 lds
    buffer_load_dwordx4 v4, s[8:11], s61 offen offset:2048 lds
    s_waitcnt lgkmcnt(8)
    v_mfma_f32_32x32x16_bf16 v[32:47], v[160:163], v[152:155], v[32:47]
    ds_read_b64_tr_b16 v[28:29], v7 offset:2048
    ds_read_b64_tr_b16 v[30:31], v7 offset:3072
    s_add_u32 s47, s47, 24576
    s_cmp_ge_u32 s47, 98304
    s_cselect_b32 s61, 98304, 0
    s_sub_u32 s47, s47, s61
    s_and_b32 s62, s100, 15
    s_bitcmp1_b32 s58, s62
    s_cselect_b32 s62, 1, 2
    s_cmp_eq_u32 s87, 0
    s_cselect_b32 s62, s62, 2
    s_waitcnt lgkmcnt(8)
    v_mfma_f32_32x32x16_bf16 v[32:47], v[164:167], v[156:159], v[32:47]
    ds_read_b64_tr_b16 v[160:161], v6 offset:4096
    ds_read_b64_tr_b16 v[162:163], v6 offset:5120
    s_cmp_eq_u32 s87, 2
    s_cselect_b32 s87, 0, s62
    s_cselect_b32 s62, 4, 0
    s_addc_u32 s88, s88, 0
    s_lshr_b32 s100, s100, s62
    s_and_b32 s62, s100, 15
    s_mul_i32 s62, s62, 221184
    s_add_u32 s86, s56, s62
    s_cmp_ge_u32 s88, 6
    s_cselect_b32 s86, 2147418112, s86
    s_bitcmp1_b32 9, s44
    s_cbranch_scc1 g2_chkASB
g2_chkASB_ret:
    s_waitcnt lgkmcnt(8)
    v_mfma_f32_32x32x16_bf16 v[80:95], v[16:19], v[112:115], v[80:95]
    ds_read_b64_tr_b16 v[164:165], v7 offset:4096
    ds_read_b64_tr_b16 v[166:167], v7 offset:5120
    s_waitcnt lgkmcnt(8)
    v_mfma_f32_32x32x16_bf16 v[96:111], v[20:23], v[112:115], v[96:111]
    ds_read_b64_tr_b16 v[16:17], v6 offset:6144
    ds_read_b64_tr_b16 v[18:19], v6 offset:7168
    buffer_load_dwordx4 v[112:115], v9, s[12:15], s52 offen offset:0 sc1
    s_waitcnt lgkmcnt(8)
    v_mfma_f32_32x32x16_bf16 v[80:95], v[24:27], v[116:119], v[80:95]
    ds_read_b64_tr_b16 v[20:21], v7 offset:6144
    ds_read_b64_tr_b16 v[22:23], v7 offset:7168
    s_waitcnt lgkmcnt(8)
    v_mfma_f32_32x32x16_bf16 v[96:111], v[28:31], v[116:119], v[96:111]
    ds_read_b64_tr_b16 v[24:25], v6 offset:8192
    ds_read_b64_tr_b16 v[26:27], v6 offset:9216
    buffer_load_dwordx4 v[116:119], v9, s[12:15], s52 offen offset:1024 sc1
    s_waitcnt lgkmcnt(8)
    v_mfma_f32_32x32x16_bf16 v[80:95], v[160:163], v[120:123], v[80:95]
    ds_read_b64_tr_b16 v[28:29], v7 offset:8192
    ds_read_b64_tr_b16 v[30:31], v7 offset:9216
    s_waitcnt lgkmcnt(8)
    v_mfma_f32_32x32x16_bf16 v[96:111], v[164:167], v[120:123], v[96:111]
    ds_read_b64_tr_b16 v[160:161], v6 offset:10240
    ds_read_b64_tr_b16 v[162:163], v6 offset:11264
    buffer_load_dwordx4 v[120:123], v9, s[12:15], s52 offen offset:2048 sc1
    s_waitcnt lgkmcnt(8)
    v_mfma_f32_32x32x16_bf16 v[80:95], v[16:19], v[124:127], v[80:95]
    ds_read_b64_tr_b16 v[164:165], v7 offset:10240
    ds_read_b64_tr_b16 v[166:167], v7 offset:11264
    s_waitcnt lgkmcnt(8)
    v_mfma_f32_32x32x16_bf16 v[96:111], v[20:23], v[124:127], v[96:111]
    ds_read_b64_tr_b16 v[16:17], v6 offset:12288
    ds_read_b64_tr_b16 v[18:19], v6 offset:13312
    buffer_load_dwordx4 v[124:127], v9, s[12:15], s52 offen offset:3072 sc1
    s_waitcnt lgkmcnt(8)
    v_mfma_f32_32x32x16_bf16 v[80:95], v[24:27], v[128:131], v[80:95]
    s_waitcnt vmcnt(10)
    s_mov_b64 exec, 1
    ds_add_u32 v15, v14
    s_mov_b64 exec, -1
    s_add_u32 s66, s66, 4
    ds_read_b64_tr_b16 v[20:21], v7 offset:12288
    ds_read_b64_tr_b16 v[22:23], v7 offset:13312
    s_waitcnt lgkmcnt(9)
    v_mfma_f32_32x32x16_bf16 v[96:111], v[28:31], v[128:131], v[96:111]
    ds_read_b64_tr_b16 v[24:25], v6 offset:14336
    ds_read_b64_tr_b16 v[26:27], v6 offset:15360
    s_add_u32 s52, s52, 4096
    buffer_load_dwordx4 v[128:131], v9, s[12:15], s52 offen offset:0 sc1
    s_waitcnt lgkmcnt(9)
    v_mfma_f32_32x32x16_bf16 v[80:95], v[160:163], v[132:135], v[80:95]
    ds_read_b64_tr_b16 v[28:29], v7 offset:14336
    ds_read_b64_tr_b16 v[30:31], v7 offset:15360
    s_waitcnt lgkmcnt(9)
    v_mfma_f32_32x32x16_bf16 v[96:111], v[164:167], v[132:135], v[96:111]
    ds_read_b64_tr_b16 v[160:161], v6 offset:16384
    ds_read_b64_tr_b16 v[162:163], v6 offset:17408
    buffer_load_dwordx4 v[132:135], v9, s[12:15], s52 offen offset:1024 sc1
    s_waitcnt lgkmcnt(9)
    v_mfma_f32_32x32x16_bf16 v[80:95], v[16:19], v[136:139], v[80:95]
    ds_read_b64_tr_b16 v[164:165], v7 offset:16384
    ds_read_b64_tr_b16 v[166:167], v7 offset:17408
    s_waitcnt lgkmcnt(8)
    v_mfma_f32_32x32x16_bf16 v[96:111], v[20:23], v[136:139], v[96:111]
    ds_read_b32 v13, v15
    ds_read_b64_tr_b16 v[16:17], v6 offset:18432
    ds_read_b64_tr_b16 v[18:19], v6 offset:19456
    buffer_load_dwordx4 v[136:139], v9, s[12:15], s52 offen offset:2048 sc1
    s_waitcnt lgkmcnt(9)
    v_mfma_f32_32x32x16_bf16 v[80:95], v[24:27], v[140:143], v[80:95]
    ds_read_b64_tr_b16 v[20:21], v7 offset:18432
    ds_read_b64_tr_b16 v[22:23], v7 offset:19456
    s_waitcnt lgkmcnt(9)
    v_mfma_f32_32x32x16_bf16 v[96:111], v[28:31], v[140:143], v[96:111]
    ds_read_b64_tr_b16 v[24:25], v6 offset:20480
    ds_read_b64_tr_b16 v[26:27], v6 offset:21504
    buffer_load_dwordx4 v[140:143], v9, s[12:15], s52 offen offset:3072 sc1
    s_waitcnt lgkmcnt(9)
    v_mfma_f32_32x32x16_bf16 v[80:95], v[160:163], v[144:147], v[80:95]
    ds_read_b64_tr_b16 v[28:29], v7 offset:20480
    ds_read_b64_tr_b16 v[30:31], v7 offset:21504
    s_waitcnt lgkmcnt(9)
    v_mfma_f32_32x32x16_bf16 v[96:111], v[164:167], v[144:147], v[96:111]
    s_waitcnt lgkmcnt(8)
    v_readfirstlane_b32 s60, v13
    s_cmp_lt_u32 s60, s66
    s_cbranch_scc1 g2_pollASBB
g2_pollASBB_ret:
    ds_read_b64_tr_b16 v[160:161], v6 offset:22528
    ds_read_b64_tr_b16 v[162:163], v6 offset:23552
    s_add_u32 s62, s89, 128
    s_cmp_eq_u32 s87, 0
    s_cselect_b32 s62, s89, s62
    s_cmp_eq_u32 s87, 1
    s_cselect_b32 s62, s48, s62
    s_add_u32 s62, s62, s86
    s_add_u32 s52, s52, 4096
    buffer_load_dwordx4 v[144:147], v9, s[12:15], s52 offen offset:0 sc1
    s_waitcnt lgkmcnt(8)
    v_mfma_f32_32x32x16_bf16 v[80:95], v[16:19], v[148:151], v[80:95]
    ds_read_b64_tr_b16 v[164:165], v7 offset:22528
    ds_read_b64_tr_b16 v[166:167], v7 offset:23552
    s_add_u32 m0, s47, 0
    s_add_u32 s61, s62, 0
    buffer_load_dwordx4 v2, s[8:11], s61 offen offset:0 lds
    s_waitcnt lgkmcnt(8)
    v_mfma_f32_32x32x16_bf16 v[96:111], v[20:23], v[148:151], v[96:111]
    v_add_u32 v6, s46, v5
    v_xor_b32 v7, 64, v6
    s_add_u32 s46, s46, 24576
    s_cmp_ge_u32 s46, 98304
    s_cselect_b32 s46, 0, s46
    ds_read_b64_tr_b16 v[16:17], v6 offset:0
    ds_read_b64_tr_b16 v[18:19], v6 offset:1024
    buffer_load_dwordx4 v3, s[8:11], s61 offen offset:1024 lds
    buffer_load_dwordx4 v4, s[8:11], s61 offen offset:2048 lds
    buffer_load_dwordx4 v[148:151], v9, s[12:15], s52 offen offset:1024 sc1
    s_waitcnt lgkmcnt(8)
    v_mfma_f32_32x32x16_bf16 v[80:95], v[24:27], v[152:155], v[80:95]
    ds_read_b64_tr_b16 v[20:21], v7 offset:0
    ds_read_b64_tr_b16 v[22:23], v7 offset:1024
    s_add_u32 m0, s47, 3072
    s_add_u32 s61, s62, 27648
    buffer_load_dwordx4 v2, s[8:11], s61 offen offset:0 lds
    buffer_load_dwordx4 v3, s[8:11], s61 offen offset:1024 lds
    s_waitcnt lgkmcnt(8)
    v_mfma_f32_32x32x16_bf16 v[96:111], v[28:31], v[152:155], v[96:111]
    ds_read_b64_tr_b16 v[24:25], v6 offset:2048
    ds_read_b64_tr_b16 v[26:27], v6 offset:3072
    buffer_load_dwordx4 v4, s[8:11], s61 offen offset:2048 lds
    s_add_u32 s47, s47, 24576
    s_cmp_ge_u32 s47, 98304
    s_cselect_b32 s61, 98304, 0
    s_sub_u32 s47, s47, s61
    buffer_load_dwordx4 v[152:155], v9, s[12:15], s52 offen offset:2048 sc1
    s_waitcnt lgkmcnt(8)
    v_mfma_f32_32x32x16_bf16 v[80:95], v[160:163], v[156:159], v[80:95]
    ds_read_b64_tr_b16 v[28:29], v7 offset:2048
    ds_read_b64_tr_b16 v[30:31], v7 offset:3072
    s_and_b32 s62, s100, 15
    s_bitcmp1_b32 s58, s62
    s_cselect_b32 s62, 1, 2
    s_cmp_eq_u32 s87, 0
    s_cselect_b32 s62, s62, 2
    s_waitcnt lgkmcnt(8)
    v_mfma_f32_32x32x16_bf16 v[96:111], v[164:167], v[156:159], v[96:111]
    ds_read_b64_tr_b16 v[160:161], v6 offset:4096
    ds_read_b64_tr_b16 v[162:163], v6 offset:5120
    s_cmp_eq_u32 s87, 2
    s_cselect_b32 s87, 0, s62
    s_cselect_b32 s62, 4, 0
    s_addc_u32 s88, s88, 0
    s_lshr_b32 s100, s100, s62
    s_and_b32 s62, s100, 15
    s_mul_i32 s62, s62, 221184
    s_add_u32 s86, s56, s62
    s_cmp_ge_u32 s88, 6
    s_cselect_b32 s86, 2147418112, s86
    buffer_load_dwordx4 v[156:159], v9, s[12:15], s52 offen offset:3072 sc1
    s_add_u32 s52, s52, 4096
    s_branch g2_next
g2_pollASBA:
    ds_read_b32 v13, v15
    s_waitcnt lgkmcnt(0)
    v_readfirstlane_b32 s60, v13
    s_cmp_lt_u32 s60, s66
    s_cbranch_scc1 g2_pollASBA
    s_branch g2_pollASBA_ret
g2_pollASBS:
    ds_read_b32 v13, v15
    s_waitcnt lgkmcnt(0)
    v_readfirstlane_b32 s60, v13
    s_cmp_lt_u32 s60, s66
    s_cbranch_scc1 g2_pollASBS
    s_branch g2_pollASBS_ret
g2_pollASBB:
    ds_read_b32 v13, v15
    s_waitcnt lgkmcnt(0)
    v_readfirstlane_b32 s60, v13
    s_cmp_lt_u32 s60, s66
    s_cbranch_scc1 g2_pollASBB
    s_branch g2_pollASBB_ret
g2_pollABA:
    ds_read_b32 v13, v15
    s_waitcnt lgkmcnt(0)
    v_readfirstlane_b32 s60, v13
    s_cmp_lt_u32 s60, s66
    s_cbranch_scc1 g2_pollABA
    s_branch g2_pollABA_ret
g2_pollABB:
    ds_read_b32 v13, v15
    s_waitcnt lgkmcnt(0)
    v_readfirstlane_b32 s60, v13
    s_cmp_lt_u32 s60, s66
    s_cbranch_scc1 g2_pollABB
    s_branch g2_pollABB_ret
g2_chkASB:
    s_buffer_load_dwordx4 s[28:31], s[12:15], s64 glc
    s_add_u32 s65, s65, 1
    s_waitcnt lgkmcnt(0)
    s_cmp_eq_u32 s44, 0
    s_cselect_b32 s30, 1, s30
    s_and_b32 s60, s28, s29
    s_and_b32 s30, s30, s31
    s_and_b32 s60, s60, s30
    s_cmp_ge_u32 s65, 32768
    s_cbranch_scc1 g2_chkASB_ret
    s_cmp_eq_u32 s60, 1
    s_cbranch_scc1 g2_chkASB_ret
    s_sleep 2
    s_branch g2_chkASB
g2_chkAB:
    s_buffer_load_dwordx4 s[28:31], s[12:15], s64 glc
    s_add_u32 s65, s65, 1
    s_waitcnt lgkmcnt(0)
    s_cmp_eq_u32 s44, 0
    s_cselect_b32 s30, 1, s30
    s_and_b32 s60, s28, s29
    s_and_b32 s30, s30, s31
    s_and_b32 s60, s60, s30
    s_cmp_ge_u32 s65, 32768
    s_cbranch_scc1 g2_chkAB_ret
    s_cmp_eq_u32 s60, 1
    s_cbranch_scc1 g2_chkAB_ret
    s_sleep 2
    s_branch g2_chkAB
g2_ab:
    s_waitcnt vmcnt(11) lgkmcnt(8)
    v_mfma_f32_32x32x16_bf16 v[48:63], v[16:19], v[112:115], v[48:63]
    ds_read_b64_tr_b16 v[164:165], v7 offset:4096
    ds_read_b64_tr_b16 v[166:167], v7 offset:5120
    s_waitcnt lgkmcnt(8)
    v_mfma_f32_32x32x16_bf16 v[64:79], v[20:23], v[112:115], v[64:79]
    ds_read_b64_tr_b16 v[16:17], v6 offset:6144
    ds_read_b64_tr_b16 v[18:19], v6 offset:7168
    s_waitcnt vmcnt(10) lgkmcnt(8)
    v_mfma_f32_32x32x16_bf16 v[48:63], v[24:27], v[116:119], v[48:63]
    ds_read_b64_tr_b16 v[20:21], v7 offset:6144
    ds_read_b64_tr_b16 v[22:23], v7 offset:7168
    s_waitcnt lgkmcnt(8)
    v_mfma_f32_32x32x16_bf16 v[64:79], v[28:31], v[116:119], v[64:79]
    ds_read_b64_tr_b16 v[24:25], v6 offset:8192
    ds_read_b64_tr_b16 v[26:27], v6 offset:9216
    s_waitcnt vmcnt(9) lgkmcnt(8)
    v_mfma_f32_32x32x16_bf16 v[48:63], v[160:163], v[120:123], v[48:63]
    ds_read_b64_tr_b16 v[28:29], v7 offset:8192
    ds_read_b64_tr_b16 v[30:31], v7 offset:9216
    s_waitcnt lgkmcnt(8)
    v_mfma_f32_32x32x16_bf16 v[64:79], v[164:167], v[120:123], v[64:79]
    ds_read_b64_tr_b16 v[160:161], v6 offset:10240
    ds_read_b64_tr_b16 v[162:163], v6 offset:11264
    s_waitcnt vmcnt(8) lgkmcnt(8)
    v_mfma_f32_32x32x16_bf16 v[48:63], v[16:19], v[124:127], v[48:63]
    ds_read_b64_tr_b16 v[164:165], v7 offset:10240
    ds_read_b64_tr_b16 v[166:167], v7 offset:11264
    s_waitcnt lgkmcnt(8)
    v_mfma_f32_32x32x16_bf16 v[64:79], v[20:23], v[124:127], v[64:79]
    ds_read_b64_tr_b16 v[16:17], v6 offset:12288
    ds_read_b64_tr_b16 v[18:19], v6 offset:13312
    s_waitcnt vmcnt(7) lgkmcnt(8)
    v_mfma_f32_32x32x16_bf16 v[48:63], v[24:27], v[128:131], v[48:63]
    s_waitcnt vmcnt(63)
    s_mov_b64 exec, 1
    ds_add_u32 v15, v14
    s_mov_b64 exec, -1
    s_add_u32 s66, s66, 4
    ds_read_b64_tr_b16 v[20:21], v7 offset:12288
    ds_read_b64_tr_b16 v[22:23], v7 offset:13312
    s_waitcnt lgkmcnt(9)
    v_mfma_f32_32x32x16_bf16 v[64:79], v[28:31], v[128:131], v[64:79]
    ds_read_b64_tr_b16 v[24:25], v6 offset:14336
    ds_read_b64_tr_b16 v[26:27], v6 offset:15360
    s_waitcnt vmcnt(6) lgkmcnt(9)
    v_mfma_f32_32x32x16_bf16 v[48:63], v[160:163], v[132:135], v[48:63]
    ds_read_b64_tr_b16 v[28:29], v7 offset:14336
    ds_read_b64_tr_b16 v[30:31], v7 offset:15360
    s_waitcnt lgkmcnt(9)
    v_mfma_f32_32x32x16_bf16 v[64:79], v[164:167], v[132:135], v[64:79]
    ds_read_b64_tr_b16 v[160:161], v6 offset:16384
    ds_read_b64_tr_b16 v[162:163], v6 offset:17408
    s_waitcnt vmcnt(5) lgkmcnt(9)
    v_mfma_f32_32x32x16_bf16 v[48:63], v[16:19], v[136:139], v[48:63]
    ds_read_b64_tr_b16 v[164:165], v7 offset:16384
    ds_read_b64_tr_b16 v[166:167], v7 offset:17408
    s_waitcnt lgkmcnt(8)
    v_mfma_f32_32x32x16_bf16 v[64:79], v[20:23], v[136:139], v[64:79]
    ds_read_b32 v13, v15
    ds_read_b64_tr_b16 v[16:17], v6 offset:18432
    ds_read_b64_tr_b16 v[18:19], v6 offset:19456
    s_waitcnt vmcnt(4) lgkmcnt(9)
    v_mfma_f32_32x32x16_bf16 v[48:63], v[24:27], v[140:143], v[48:63]
    ds_read_b64_tr_b16 v[20:21], v7 offset:18432
    ds_read_b64_tr_b16 v[22:23], v7 offset:19456
    s_waitcnt lgkmcnt(9)
    v_mfma_f32_32x32x16_bf16 v[64:79], v[28:31], v[140:143], v[64:79]
    ds_read_b64_tr_b16 v[24:25], v6 offset:20480
    ds_read_b64_tr_b16 v[26:27], v6 offset:21504
    s_waitcnt vmcnt(3) lgkmcnt(9)
    v_mfma_f32_32x32x16_bf16 v[48:63], v[160:163], v[144:147], v[48:63]
    ds_read_b64_tr_b16 v[28:29], v7 offset:20480
    ds_read_b64_tr_b16 v[30:31], v7 offset:21504
    s_waitcnt lgkmcnt(9)
    v_mfma_f32_32x32x16_bf16 v[64:79], v[164:167], v[144:147], v[64:79]
    s_waitcnt lgkmcnt(8)
    v_readfirstlane_b32 s60, v13
    s_cmp_lt_u32 s60, s66
    s_cbranch_scc1 g2_pollABA
g2_pollABA_ret:
    ds_read_b64_tr_b16 v[160:161], v6 offset:22528
    ds_read_b64_tr_b16 v[162:163], v6 offset:23552
    s_add_u32 s62, s89, 128
    s_cmp_eq_u32 s87, 0
    s_cselect_b32 s62, s89, s62
    s_cmp_eq_u32 s87, 1
    s_cselect_b32 s62, s48, s62
    s_add_u32 s62, s62, s86
    s_waitcnt vmcnt(2) lgkmcnt(8)
    v_mfma_f32_32x32x16_bf16 v[48:63], v[16:19], v[148:151], v[48:63]
    ds_read_b64_tr_b16 v[164:165], v7 offset:22528
    ds_read_b64_tr_b16 v[166:167], v7 offset:23552
    s_add_u32 m0, s47, 0
    s_add_u32 s61, s62, 0
    buffer_load_dwordx4 v2, s[8:11], s61 offen offset:0 lds
    s_waitcnt lgkmcnt(8)
    v_mfma_f32_32x32x16_bf16 v[64:79], v[20:23], v[148:151], v[64:79]
    v_add_u32 v6, s46, v5
    v_xor_b32 v7, 64, v6
    s_add_u32 s46, s46, 24576
    s_cmp_ge_u32 s46, 98304
    s_cselect_b32 s46, 0, s46
    ds_read_b64_tr_b16 v[16:17], v6 offset:0
    ds_read_b64_tr_b16 v[18:19], v6 offset:1024
    buffer_load_dwordx4 v3, s[8:11], s61 offen offset:1024 lds
    buffer_load_dwordx4 v4, s[8:11], s61 offen offset:2048 lds
    s_waitcnt vmcnt(4) lgkmcnt(8)
    v_mfma_f32_32x32x16_bf16 v[48:63], v[24:27], v[152:155], v[48:63]
    ds_read_b64_tr_b16 v[20:21], v7 offset:0
    ds_read_b64_tr_b16 v[22:23], v7 offset:1024
    s_add_u32 m0, s47, 3072
    s_add_u32 s61, s62, 27648
    buffer_load_dwordx4 v2, s[8:11], s61 offen offset:0 lds
    buffer_load_dwordx4 v3, s[8:11], s61 offen offset:1024 lds
    s_waitcnt lgkmcnt(8)
    v_mfma_f32_32x32x16_bf16 v[64:79], v[28:31], v[152:155], v[64:79]
    ds_read_b64_tr_b16 v[24:25], v6 offset:2048
    ds_read_b64_tr_b16 v[26:27], v6 offset:3072
    buffer_load_dwordx4 v4, s[8:11], s61 offen offset:2048 lds
    s_add_u32 s47, s47, 24576
    s_cmp_ge_u32 s47, 98304
    s_cselect_b32 s61, 98304, 0
    s_sub_u32 s47, s47, s61
    s_waitcnt vmcnt(6) lgkmcnt(8)
    v_mfma_f32_32x32x16_bf16 v[48:63], v[160:163], v[156:159], v[48:63]
    ds_read_b64_tr_b16 v[28:29], v7 offset:2048
    ds_read_b64_tr_b16 v[30:31], v7 offset:3072
    s_and_b32 s62, s100, 15
    s_bitcmp1_b32 s58, s62
    s_cselect_b32 s62, 1, 2
    s_cmp_eq_u32 s87, 0
    s_cselect_b32 s62, s62, 2
    s_waitcnt lgkmcnt(8)
    v_mfma_f32_32x32x16_bf16 v[64:79], v[164:167], v[156:159], v[64:79]
    ds_read_b64_tr_b16 v[160:161], v6 offset:4096
    ds_read_b64_tr_b16 v[162:163], v6 offset:5120
    s_cmp_eq_u32 s87, 2
    s_cselect_b32 s87, 0, s62
    s_cselect_b32 s62, 4, 0
    s_addc_u32 s88, s88, 0
    s_lshr_b32 s100, s100, s62
    s_and_b32 s62, s100, 15
    s_mul_i32 s62, s62, 221184
    s_add_u32 s86, s56, s62
    s_cmp_ge_u32 s88, 6
    s_cselect_b32 s86, 2147418112, s86
    s_bitcmp1_b32 9, s44
    s_cbranch_scc1 g2_chkAB
g2_chkAB_ret:
    s_waitcnt lgkmcnt(8)
    v_mfma_f32_32x32x16_bf16 v[80:95], v[16:19], v[112:115], v[80:95]
    ds_read_b64_tr_b16 v[164:165], v7 offset:4096
    ds_read_b64_tr_b16 v[166:167], v7 offset:5120
    s_waitcnt lgkmcnt(8)
    v_mfma_f32_32x32x16_bf16 v[96:111], v[20:23], v[112:115], v[96:111]
    ds_read_b64_tr_b16 v[16:17], v6 offset:6144
    ds_read_b64_tr_b16 v[18:19], v6 offset:7168
    buffer_load_dwordx4 v[112:115], v9, s[12:15], s52 offen offset:0 sc1
    s_waitcnt lgkmcnt(8)
    v_mfma_f32_32x32x16_bf16 v[80:95], v[24:27], v[116:119], v[80:95]
    ds_read_b64_tr_b16 v[20:21], v7 offset:6144
    ds_read_b64_tr_b16 v[22:23], v7 offset:7168
    s_waitcnt lgkmcnt(8)
    v_mfma_f32_32x32x16_bf16 v[96:111], v[28:31], v[116:119], v[96:111]
    ds_read_b64_tr_b16 v[24:25], v6 offset:8192
    ds_read_b64_tr_b16 v[26:27], v6 offset:9216
    buffer_load_dwordx4 v[116:119], v9, s[12:15], s52 offen offset:1024 sc1
    s_waitcnt lgkmcnt(8)
    v_mfma_f32_32x32x16_bf16 v[80:95], v[160:163], v[120:123], v[80:95]
    ds_read_b64_tr_b16 v[28:29], v7 offset:8192
    ds_read_b64_tr_b16 v[30:31], v7 offset:9216
    s_waitcnt lgkmcnt(8)
    v_mfma_f32_32x32x16_bf16 v[96:111], v[164:167], v[120:123], v[96:111]
    ds_read_b64_tr_b16 v[160:161], v6 offset:10240
    ds_read_b64_tr_b16 v[162:163], v6 offset:11264
    buffer_load_dwordx4 v[120:123], v9, s[12:15], s52 offen offset:2048 sc1
    s_waitcnt lgkmcnt(8)
    v_mfma_f32_32x32x16_bf16 v[80:95], v[16:19], v[124:127], v[80:95]
    ds_read_b64_tr_b16 v[164:165], v7 offset:10240
    ds_read_b64_tr_b16 v[166:167], v7 offset:11264
    s_waitcnt lgkmcnt(8)
    v_mfma_f32_32x32x16_bf16 v[96:111], v[20:23], v[124:127], v[96:111]
    ds_read_b64_tr_b16 v[16:17], v6 offset:12288
    ds_read_b64_tr_b16 v[18:19], v6 offset:13312
    buffer_load_dwordx4 v[124:127], v9, s[12:15], s52 offen offset:3072 sc1
    s_waitcnt lgkmcnt(8)
    v_mfma_f32_32x32x16_bf16 v[80:95], v[24:27], v[128:131], v[80:95]
    s_waitcnt vmcnt(63)
    s_mov_b64 exec, 1
    ds_add_u32 v15, v14
    s_mov_b64 exec, -1
    s_add_u32 s66, s66, 4
    ds_read_b64_tr_b16 v[20:21], v7 offset:12288
    ds_read_b64_tr_b16 v[22:23], v7 offset:13312
    s_waitcnt lgkmcnt(9)
    v_mfma_f32_32x32x16_bf16 v[96:111], v[28:31], v[128:131], v[96:111]
    ds_read_b64_tr_b16 v[24:25], v6 offset:14336
    ds_read_b64_tr_b16 v[26:27], v6 offset:15360
    s_add_u32 s52, s52, 4096
    buffer_load_dwordx4 v[128:131], v9, s[12:15], s52 offen offset:0 sc1
    s_waitcnt lgkmcnt(9)
    v_mfma_f32_32x32x16_bf16 v[80:95], v[160:163], v[132:135], v[80:95]
    ds_read_b64_tr_b16 v[28:29], v7 offset:14336
    ds_read_b64_tr_b16 v[30:31], v7 offset:15360
    s_waitcnt lgkmcnt(9)
    v_mfma_f32_32x32x16_bf16 v[96:111], v[164:167], v[132:135], v[96:111]
    ds_read_b64_tr_b16 v[160:161], v6 offset:16384
    ds_read_b64_tr_b16 v[162:163], v6 offset:17408
    buffer_load_dwordx4 v[132:135], v9, s[12:15], s52 offen offset:1024 sc1
    s_waitcnt lgkmcnt(9)
    v_mfma_f32_32x32x16_bf16 v[80:95], v[16:19], v[136:139], v[80:95]
    ds_read_b64_tr_b16 v[164:165], v7 offset:16384
    ds_read_b64_tr_b16 v[166:167], v7 offset:17408
    s_waitcnt lgkmcnt(8)
    v_mfma_f32_32x32x16_bf16 v[96:111], v[20:23], v[136:139], v[96:111]
    ds_read_b32 v13, v15
    ds_read_b64_tr_b16 v[16:17], v6 offset:18432
    ds_read_b64_tr_b16 v[18:19], v6 offset:19456
    buffer_load_dwordx4 v[136:139], v9, s[12:15], s52 offen offset:2048 sc1
    s_waitcnt lgkmcnt(9)
    v_mfma_f32_32x32x16_bf16 v[80:95], v[24:27], v[140:143], v[80:95]
    ds_read_b64_tr_b16 v[20:21], v7 offset:18432
    ds_read_b64_tr_b16 v[22:23], v7 offset:19456
    s_waitcnt lgkmcnt(9)
    v_mfma_f32_32x32x16_bf16 v[96:111], v[28:31], v[140:143], v[96:111]
    ds_read_b64_tr_b16 v[24:25], v6 offset:20480
    ds_read_b64_tr_b16 v[26:27], v6 offset:21504
    buffer_load_dwordx4 v[140:143], v9, s[12:15], s52 offen offset:3072 sc1
    s_waitcnt lgkmcnt(9)
    v_mfma_f32_32x32x16_bf16 v[80:95], v[160:163], v[144:147], v[80:95]
    ds_read_b64_tr_b16 v[28:29], v7 offset:20480
    ds_read_b64_tr_b16 v[30:31], v7 offset:21504
    s_waitcnt lgkmcnt(9)
    v_mfma_f32_32x32x16_bf16 v[96:111], v[164:167], v[144:147], v[96:111]
    s_waitcnt lgkmcnt(8)
    v_readfirstlane_b32 s60, v13
    s_cmp_lt_u32 s60, s66
    s_cbranch_scc1 g2_pollABB
g2_pollABB_ret:
    ds_read_b64_tr_b16 v[160:161], v6 offset:22528
    ds_read_b64_tr_b16 v[162:163], v6 offset:23552
    s_add_u32 s62, s89, 128
    s_cmp_eq_u32 s87, 0
    s_cselect_b32 s62, s89, s62
    s_cmp_eq_u32 s87, 1
    s_cselect_b32 s62, s48, s62
    s_add_u32 s62, s62, s86
    s_add_u32 s52, s52, 4096
    buffer_load_dwordx4 v[144:147], v9, s[12:15], s52 offen offset:0 sc1
    s_waitcnt lgkmcnt(8)
    v_mfma_f32_32x32x16_bf16 v[80:95], v[16:19], v[148:151], v[80:95]
    ds_read_b64_tr_b16 v[164:165], v7 offset:22528
    ds_read_b64_tr_b16 v[166:167], v7 offset:23552
    s_add_u32 m0, s47, 0
    s_add_u32 s61, s62, 0
    buffer_load_dwordx4 v2, s[8:11], s61 offen offset:0 lds
    s_waitcnt lgkmcnt(8)
    v_mfma_f32_32x32x16_bf16 v[96:111], v[20:23], v[148:151], v[96:111]
    v_add_u32 v6, s46, v5
    v_xor_b32 v7, 64, v6
    s_add_u32 s46, s46, 24576
    s_cmp_ge_u32 s46, 98304
    s_cselect_b32 s46, 0, s46
    ds_read_b64_tr_b16 v[16:17], v6 offset:0
    ds_read_b64_tr_b16 v[18:19], v6 offset:1024
    buffer_load_dwordx4 v3, s[8:11], s61 offen offset:1024 lds
    buffer_load_dwordx4 v4, s[8:11], s61 offen offset:2048 lds
    buffer_load_dwordx4 v[148:151], v9, s[12:15], s52 offen offset:1024 sc1
    s_waitcnt lgkmcnt(8)
    v_mfma_f32_32x32x16_bf16 v[80:95], v[24:27], v[152:155], v[80:95]
    ds_read_b64_tr_b16 v[20:21], v7 offset:0
    ds_read_b64_tr_b16 v[22:23], v7 offset:1024
    s_add_u32 m0, s47, 3072
    s_add_u32 s61, s62, 27648
    buffer_load_dwordx4 v2, s[8:11], s61 offen offset:0 lds
    buffer_load_dwordx4 v3, s[8:11], s61 offen offset:1024 lds
    s_waitcnt lgkmcnt(8)
    v_mfma_f32_32x32x16_bf16 v[96:111], v[28:31], v[152:155], v[96:111]
    ds_read_b64_tr_b16 v[24:25], v6 offset:2048
    ds_read_b64_tr_b16 v[26:27], v6 offset:3072
    buffer_load_dwordx4 v4, s[8:11], s61 offen offset:2048 lds
    s_add_u32 s47, s47, 24576
    s_cmp_ge_u32 s47, 98304
    s_cselect_b32 s61, 98304, 0
    s_sub_u32 s47, s47, s61
    buffer_load_dwordx4 v[152:155], v9, s[12:15], s52 offen offset:2048 sc1
    s_waitcnt lgkmcnt(8)
    v_mfma_f32_32x32x16_bf16 v[80:95], v[160:163], v[156:159], v[80:95]
    ds_read_b64_tr_b16 v[28:29], v7 offset:2048
    ds_read_b64_tr_b16 v[30:31], v7 offset:3072
    s_and_b32 s62, s100, 15
    s_bitcmp1_b32 s58, s62
    s_cselect_b32 s62, 1, 2
    s_cmp_eq_u32 s87, 0
    s_cselect_b32 s62, s62, 2
    s_waitcnt lgkmcnt(8)
    v_mfma_f32_32x32x16_bf16 v[96:111], v[164:167], v[156:159], v[96:111]
    ds_read_b64_tr_b16 v[160:161], v6 offset:4096
    ds_read_b64_tr_b16 v[162:163], v6 offset:5120
    s_cmp_eq_u32 s87, 2
    s_cselect_b32 s87, 0, s62
    s_cselect_b32 s62, 4, 0
    s_addc_u32 s88, s88, 0
    s_lshr_b32 s100, s100, s62
    s_and_b32 s62, s100, 15
    s_mul_i32 s62, s62, 221184
    s_add_u32 s86, s56, s62
    s_cmp_ge_u32 s88, 6
    s_cselect_b32 s86, 2147418112, s86
    buffer_load_dwordx4 v[156:159], v9, s[12:15], s52 offen offset:3072 sc1
    s_add_u32 s52, s52, 4096
g2_next:
    s_add_u32 s44, s44, 1
    s_cmp_lt_u32 s44, 6
    s_cbranch_scc1 g2_loop
    s_lshl_b32 s60, s59, 13
    s_add_u32 s60, s60, s63
    s_add_u32 s61, s60, 4096
    s_lshr_b32 s62, s59, 1
    s_add_u32 s62, s62, s38
    s_mul_i32 s62, s62, 2359296
    s_add_u32 s62, s62, s63
    s_and_b32 s64, s59, 1
    s_lshl_b32 s64, s64, 11
    s_add_u32 s62, s62, s64
    s_add_u32 s62, s62, 32768
    v_cvt_pk_bf16_f32 v32, v32, v33
    v_cvt_pk_bf16_f32 v33, v34, v35
    v_cvt_pk_bf16_f32 v34, v36, v37
    v_cvt_pk_bf16_f32 v35, v38, v39
    v_cvt_pk_bf16_f32 v36, v40, v41
    v_cvt_pk_bf16_f32 v37, v42, v43
    v_cvt_pk_bf16_f32 v38, v44, v45
    v_cvt_pk_bf16_f32 v39, v46, v47
    buffer_store_dwordx4 v[32:35], v9, s[12:15], s62 offen offset:0 sc1
    buffer_store_dwordx4 v[36:39], v9, s[12:15], s62 offen offset:1024 sc1
    v_cvt_pk_bf16_f32 v48, v48, v49
    v_cvt_pk_bf16_f32 v49, v50, v51
    v_cvt_pk_bf16_f32 v50, v52, v53
    v_cvt_pk_bf16_f32 v51, v54, v55
    v_cvt_pk_bf16_f32 v52, v56, v57
    v_cvt_pk_bf16_f32 v53, v58, v59
    v_cvt_pk_bf16_f32 v54, v60, v61
    v_cvt_pk_bf16_f32 v55, v62, v63
    buffer_store_dwordx4 v[48:51], v9, s[12:15], s60 offen offset:0 sc1
    buffer_store_dwordx4 v[52:55], v9, s[12:15], s60 offen offset:1024 sc1
    v_cvt_pk_bf16_f32 v64, v64, v65
    v_cvt_pk_bf16_f32 v65, v66, v67
    v_cvt_pk_bf16_f32 v66, v68, v69
    v_cvt_pk_bf16_f32 v67, v70, v71
    v_cvt_pk_bf16_f32 v68, v72, v73
    v_cvt_pk_bf16_f32 v69, v74, v75
    v_cvt_pk_bf16_f32 v70, v76, v77
    v_cvt_pk_bf16_f32 v71, v78, v79
    buffer_store_dwordx4 v[64:67], v9, s[12:15], s60 offen offset:2048 sc1
    buffer_store_dwordx4 v[68:71], v9, s[12:15], s60 offen offset:3072 sc1
    v_cvt_pk_bf16_f32 v80, v80, v81
    v_cvt_pk_bf16_f32 v81, v82, v83
    v_cvt_pk_bf16_f32 v82, v84, v85
    v_cvt_pk_bf16_f32 v83, v86, v87
    v_cvt_pk_bf16_f32 v84, v88, v89
    v_cvt_pk_bf16_f32 v85, v90, v91
    v_cvt_pk_bf16_f32 v86, v92, v93
    v_cvt_pk_bf16_f32 v87, v94, v95
    buffer_store_dwordx4 v[80:83], v9, s[12:15], s61 offen offset:0 sc1
    buffer_store_dwordx4 v[84:87], v9, s[12:15], s61 offen offset:1024 sc1
    v_cvt_pk_bf16_f32 v96, v96, v97
    v_cvt_pk_bf16_f32 v97, v98, v99
    v_cvt_pk_bf16_f32 v98, v100, v101
    v_cvt_pk_bf16_f32 v99, v102, v103
    v_cvt_pk_bf16_f32 v100, v104, v105
    v_cvt_pk_bf16_f32 v101, v106, v107
    v_cvt_pk_bf16_f32 v102, v108, v109
    v_cvt_pk_bf16_f32 v103, v110, v111
    buffer_store_dwordx4 v[96:99], v9, s[12:15], s61 offen offset:2048 sc1
    buffer_store_dwordx4 v[100:103], v9, s[12:15], s61 offen offset:3072 sc1
    s_load_dwordx2 s[32:33], s[0:1], 32
    s_load_dwordx4 s[28:31], s[0:1], 72
    s_lshl_b32 s64, s42, 4
    s_add_u32 s65, s64, s41
    s_lshl_b32 s65, s65, 7
    s_add_u32 s65, s65, 22610000
    s_lshl_b32 s64, s64, 7
    s_add_u32 s64, s64, s41
    s_add_u32 s67, s64, 22610000
    s_lshl_b32 s42, s42, 1
    s_lshr_b32 s60, s41, 3
    s_add_u32 s42, s42, s60
    s_and_b32 s41, s41, 7
    v_mov_b32 v24, 159748
    v_mov_b32 v25, 1
    s_lshl_b32 s43, s42, 1
    s_lshr_b32 s62, s40, 1
    s_add_u32 s43, s43, s62
    s_and_b32 s48, s40, 1
    s_lshl_b32 s49, s41, 1
    s_add_u32 s49, s49, s48
    s_lshr_b32 s60, s41, 1
    s_cmp_eq_u32 s60, s62
    s_cselect_b32 s50, 1, 0
    v_lshrrev_b32 v10, 3, v1
    v_and_b32 v11, 7, v1
    v_lshlrev_b32 v253, 4, v11
    v_bfe_u32 v12, v1, 4, 1
    v_lshlrev_b32 v12, 2, v12
    v_xor_b32 v11, v11, v12
    v_lshlrev_b32 v11, 4, v11
    v_mul_u32_u24 v12, 1152, v10
    v_add_u32 v252, v12, v253
    v_add_u32 v2, v12, v11
    v_lshrrev_b32 v12, 1, v10
    v_mul_u32_u24 v12, 18, v12
    v_and_b32 v13, 1, v10
    v_add_u32 v12, v12, v13
    v_mul_u32_u24 v12, 1152, v12
    v_add_u32 v3, v12, v11
    v_lshrrev_b32 v10, 2, v1
    v_and_b32 v11, 3, v1
    v_lshlrev_b32 v255, 4, v11
    v_mul_u32_u24 v12, 1152, v10
    v_add_u32 v4, v12, v255
    v_lshrrev_b32 v12, 1, v10
    v_mul_u32_u24 v12, 18, v12
    v_and_b32 v13, 1, v10
    v_add_u32 v12, v12, v13
    v_mul_u32_u24 v12, 1152, v12
    v_add_u32 v14, v12, v255
    s_waitcnt lgkmcnt(0)
    s_mov_b32 s8, s32
    s_mov_b32 s9, s33
    s_mov_b32 s10, 663552
    s_mov_b32 s11, 0x00020000
    s_mov_b32 s16, s28
    s_mov_b32 s17, s29
    s_mov_b32 s18, 1152
    s_mov_b32 s19, 0x00020000
    s_mov_b32 s20, s30
    s_mov_b32 s21, s31
    s_mov_b32 s22, 2359296
    s_mov_b32 s23, 0x00020000
    s_waitcnt vmcnt(0)
    s_mov_b64 exec, 1
    ds_add_u32 v24, v25
    ds_add_rtn_u32 v26, v24, v25 offset:24
    s_mov_b64 exec, -1
    s_add_u32 s66, s66, 4
    s_waitcnt lgkmcnt(0)
    v_readfirstlane_b32 s60, v26
    s_cmp_lg_u32 s60, 7
    s_cbranch_scc1 t_nopub
    v_lshlrev_b32 v26, 7, v1
    s_mov_b64 exec, 0xffff
    buffer_store_byte v25, v26, s[12:15], s67 offen sc1
    s_mov_b64 exec, -1
t_nopub:
t_gb:
    ds_read_b32 v26, v24
    s_waitcnt lgkmcnt(0)
    v_readfirstlane_b32 s60, v26
    s_cmp_lt_u32 s60, s66
    s_cbranch_scc1 t_gb
    s_lshl_b32 s61, s41, 7
    s_mul_i32 s60, s40, 165888
    s_add_u32 s60, s60, s61
    s_lshl_b32 s62, s40, 14
    s_add_u32 m0, s62, 0
    s_add_u32 s63, s60, 0
    buffer_load_dwordx4 v2, s[8:11], s63 offen lds
    s_add_u32 m0, s62, 1024
    s_add_u32 s63, s60, 9216
    buffer_load_dwordx4 v2, s[8:11], s63 offen lds
    s_add_u32 m0, s62, 2048
    s_add_u32 s63, s60, 20736
    buffer_load_dwordx4 v2, s[8:11], s63 offen lds
    s_add_u32 m0, s62, 3072
    s_add_u32 s63, s60, 29952
    buffer_load_dwordx4 v2, s[8:11], s63 offen lds
    s_add_u32 m0, s62, 4096
    s_add_u32 s63, s60, 41472
    buffer_load_dwordx4 v2, s[8:11], s63 offen lds
    s_add_u32 m0, s62, 5120
    s_add_u32 s63, s60, 50688
    buffer_load_dwordx4 v2, s[8:11], s63 offen lds
    s_add_u32 m0, s62, 6144
    s_add_u32 s63, s60, 62208
    buffer_load_dwordx4 v2, s[8:11], s63 offen lds
    s_add_u32 m0, s62, 7168
    s_add_u32 s63, s60, 71424
    buffer_load_dwordx4 v2, s[8:11], s63 offen lds
    s_add_u32 m0, s62, 8192
    s_add_u32 s63, s60, 82944
    buffer_load_dwordx4 v2, s[8:11], s63 offen lds
    s_add_u32 m0, s62, 9216
    s_add_u32 s63, s60, 92160
    buffer_load_dwordx4 v2, s[8:11], s63 offen lds
    s_add_u32 m0, s62, 10240
    s_add_u32 s63, s60, 103680
    buffer_load_dwordx4 v2, s[8:11], s63 offen lds
    s_add_u32 m0, s62, 11264
    s_add_u32 s63, s60, 112896
    buffer_load_dwordx4 v2, s[8:11], s63 offen lds
    s_add_u32 m0, s62, 12288
    s_add_u32 s63, s60, 124416
    buffer_load_dwordx4 v2, s[8:11], s63 offen lds
    s_add_u32 m0, s62, 13312
    s_add_u32 s63, s60, 133632
    buffer_load_dwordx4 v2, s[8:11], s63 offen lds
    s_add_u32 m0, s62, 14336
    s_add_u32 s63, s60, 145152
    buffer_load_dwordx4 v2, s[8:11], s63 offen lds
    s_add_u32 m0, s62, 15360
    s_add_u32 s63, s60, 154368
    buffer_load_dwordx4 v2, s[8:11], s63 offen lds
    s_mul_i32 s60, s40, 165888
    s_add_u32 s60, s60, s61
    s_lshl_b32 s62, s40, 11
    s_add_u32 m0, s62, 65536
    s_add_u32 s63, s60, 18432
    buffer_load_dwordx4 v3, s[8:11], s63 offen lds
    s_add_u32 m0, s62, 66560
    s_add_u32 s63, s60, 101376
    buffer_load_dwordx4 v3, s[8:11], s63 offen lds
t_aw:
    s_sleep 1
    ds_read_b32 v26, v24 offset:24
    s_waitcnt lgkmcnt(0)
    v_readfirstlane_b32 s60, v26
    s_cmp_lt_u32 s60, 8
    s_cbranch_scc1 t_aw
    s_cmp_ge_u32 s41, 4
    s_cbranch_scc1 k3_noxl
    s_and_b32 s51, s41, 1
    s_lshl_b32 s51, s51, 6
    s_add_u32 s51, s51, 1024
    s_mul_i32 s60, s40, 165888
    s_add_u32 s60, s60, s51
    s_lshl_b32 s62, s40, 13
    s_add_u32 m0, s62, 73728
    s_add_u32 s63, s60, 0
    buffer_load_dwordx4 v4, s[8:11], s63 offen lds
    s_add_u32 m0, s62, 74752
    s_add_u32 s63, s60, 20736
    buffer_load_dwordx4 v4, s[8:11], s63 offen lds
    s_add_u32 m0, s62, 75776
    s_add_u32 s63, s60, 41472
    buffer_load_dwordx4 v4, s[8:11], s63 offen lds
    s_add_u32 m0, s62, 76800
    s_add_u32 s63, s60, 62208
    buffer_load_dwordx4 v4, s[8:11], s63 offen lds
    s_add_u32 m0, s62, 77824
    s_add_u32 s63, s60, 82944
    buffer_load_dwordx4 v4, s[8:11], s63 offen lds
    s_add_u32 m0, s62, 78848
    s_add_u32 s63, s60, 103680
    buffer_load_dwordx4 v4, s[8:11], s63 offen lds
    s_add_u32 m0, s62, 79872
    s_add_u32 s63, s60, 124416
    buffer_load_dwordx4 v4, s[8:11], s63 offen lds
    s_add_u32 m0, s62, 80896
    s_add_u32 s63, s60, 145152
    buffer_load_dwordx4 v4, s[8:11], s63 offen lds
    s_mul_i32 s60, s40, 165888
    s_add_u32 s60, s60, s51
    s_lshl_b32 s62, s40, 10
    s_add_u32 m0, s62, 106496
    s_add_u32 s63, s60, 18432
    buffer_load_dwordx4 v14, s[8:11], s63 offen lds
    s_lshl_b32 s60, s42, 1
    s_lshr_b32 s62, s41, 1
    s_add_u32 s60, s60, s62
    s_mul_i32 s58, s60, 36864
    s_mul_i32 s62, s40, 9216
    s_add_u32 s58, s58, s62
    s_add_u32 s58, s58, s51
    buffer_load_dwordx4 v[244:247], v4, s[4:7], s58 offen
    buffer_load_dwordx4 v[248:251], v255, s[16:19], s51 offen
k3_noxl:
    s_mul_i32 s56, s42, 73728
    s_mul_i32 s60, s40, 18432
    s_add_u32 s56, s56, s60
    s_add_u32 s56, s56, s61
    s_add_u32 s57, s56, 9216
    buffer_load_dwordx4 v[232:235], v252, s[4:7], s56 offen
    buffer_load_dwordx4 v[236:239], v252, s[4:7], s57 offen
    buffer_load_dwordx4 v[240:243], v253, s[16:19], s61 offen
    s_mul_i32 s44, s43, 18
    s_add_u32 s45, s44, 16
    s_add_u32 s44, s44, s49
    s_lshl_b32 s44, s44, 11
    s_add_u32 s44, s44, 26214400
    s_and_b32 s62, s41, 1
    s_add_u32 s45, s45, s62
    s_lshl_b32 s45, s45, 11
    s_mul_i32 s62, s48, 9437184
    s_add_u32 s45, s45, s62
    s_add_u32 s45, s45, 26214400
    s_cmp_eq_u32 s50, 0
    s_cselect_b32 s45, 2147418112, s45
    v_and_b32 v10, 31, v1
    v_lshlrev_b32 v8, 2, v10
    s_lshl_b32 s46, s43, 7
    s_add_u32 s46, s46, 22544384
    v_lshrrev_b32 v11, 5, v1
    v_lshlrev_b32 v11, 2, v11
    v_sub_u32 v10, v10, v11
    v_mov_b32 v12, 0x3f80
    v_mov_b32 v13, 0x3f800000
    v_cmp_eq_u32 vcc, 0, v10
    v_cmp_eq_u32 s[96:97], 1, v10
    s_nop 1
    v_cndmask_b32 v16, 0, v12, vcc
    v_cndmask_b32 v16, v16, v13, s[96:97]
    v_cmp_eq_u32 vcc, 2, v10
    v_cmp_eq_u32 s[96:97], 3, v10
    s_nop 1
    v_cndmask_b32 v17, 0, v12, vcc
    v_cndmask_b32 v17, v17, v13, s[96:97]
    v_cmp_eq_u32 vcc, 8, v10
    v_cmp_eq_u32 s[96:97], 9, v10
    s_nop 1
    v_cndmask_b32 v18, 0, v12, vcc
    v_cndmask_b32 v18, v18, v13, s[96:97]
    v_cmp_eq_u32 vcc, 10, v10
    v_cmp_eq_u32 s[96:97], 11, v10
    s_nop 1
    v_cndmask_b32 v19, 0, v12, vcc
    v_cndmask_b32 v19, v19, v13, s[96:97]
    v_cmp_eq_u32 vcc, 16, v10
    v_cmp_eq_u32 s[96:97], 17, v10
    s_nop 1
    v_cndmask_b32 v20, 0, v12, vcc
    v_cndmask_b32 v20, v20, v13, s[96:97]
    v_cmp_eq_u32 vcc, 18, v10
    v_cmp_eq_u32 s[96:97], 19, v10
    s_nop 1
    v_cndmask_b32 v21, 0, v12, vcc
    v_cndmask_b32 v21, v21, v13, s[96:97]
    v_cmp_eq_u32 vcc, 24, v10
    v_cmp_eq_u32 s[96:97], 25, v10
    s_nop 1
    v_cndmask_b32 v22, 0, v12, vcc
    v_cndmask_b32 v22, v22, v13, s[96:97]
    v_cmp_eq_u32 vcc, 26, v10
    v_cmp_eq_u32 s[96:97], 27, v10
    s_nop 1
    v_cndmask_b32 v23, 0, v12, vcc
    v_cndmask_b32 v23, v23, v13, s[96:97]
    s_mul_i32 s60, s48, 36864
    v_add_u32 v5, s60, v5
    v_xor_b32 v6, 64, v5
    v_bfe_u32 v12, v1, 2, 2
    v_add_u32 v12, v11, v12
    v_lshlrev_b32 v12, 6, v12
    v_bfe_u32 v13, v1, 4, 1
    v_lshl_add_u32 v12, v13, 5, v12
    v_and_b32 v13, 3, v1
    v_lshl_add_u32 v12, v13, 3, v12
    s_mul_i32 s60, s48, 18432
    s_add_u32 s60, s60, 73728
    v_add_u32 v7, s60, v12
    s_mov_b32 s59, 0
t_fp:
    s_sleep 2
    s_buffer_load_dwordx4 s[92:95], s[12:15], s65 glc
    s_add_u32 s59, s59, 1
    s_waitcnt lgkmcnt(0)
    s_and_b32 s60, s92, s93
    s_and_b32 s62, s94, s95
    s_and_b32 s60, s60, s62
    s_cmp_ge_u32 s59, 32768
    s_cbranch_scc1 t_fp_done
    s_cmp_lg_u32 s60, 0x01010101
    s_cbranch_scc1 t_fp
t_fp_done:
    s_mul_i32 s60, s43, 36864
    s_mul_i32 s62, s48, 18432
    s_add_u32 s60, s60, s62
    s_add_u32 s60, s60, 23068672
    buffer_load_dwordx4 v[160:163], v9, s[12:15], s60 offen offset:0 sc1
    buffer_load_dwordx4 v[164:167], v9, s[12:15], s60 offen offset:1024 sc1
    buffer_load_dwordx4 v[168:171], v9, s[12:15], s60 offen offset:2048 sc1
    buffer_load_dwordx4 v[172:175], v9, s[12:15], s60 offen offset:3072 sc1
    s_add_u32 s60, s60, 4096
    buffer_load_dwordx4 v[176:179], v9, s[12:15], s60 offen offset:0 sc1
    buffer_load_dwordx4 v[180:183], v9, s[12:15], s60 offen offset:1024 sc1
    buffer_load_dwordx4 v[184:187], v9, s[12:15], s60 offen offset:2048 sc1
    buffer_load_dwordx4 v[188:191], v9, s[12:15], s60 offen offset:3072 sc1
    s_add_u32 s60, s60, 4096
    buffer_load_dwordx4 v[192:195], v9, s[12:15], s60 offen offset:0 sc1
    buffer_load_dwordx4 v[196:199], v9, s[12:15], s60 offen offset:1024 sc1
    buffer_load_dwordx4 v[200:203], v9, s[12:15], s60 offen offset:2048 sc1
    buffer_load_dwordx4 v[204:207], v9, s[12:15], s60 offen offset:3072 sc1
    s_add_u32 s60, s60, 4096
    buffer_load_dwordx4 v[208:211], v9, s[12:15], s60 offen offset:0 sc1
    buffer_load_dwordx4 v[212:215], v9, s[12:15], s60 offen offset:1024 sc1
    buffer_load_dwordx4 v[216:219], v9, s[12:15], s60 offen offset:2048 sc1
    buffer_load_dwordx4 v[220:223], v9, s[12:15], s60 offen offset:3072 sc1
    s_add_u32 s60, s60, 4096
    buffer_load_dwordx4 v[224:227], v9, s[12:15], s60 offen offset:0 sc1
    buffer_load_dwordx4 v[228:231], v9, s[12:15], s60 offen offset:1024 sc1
    s_waitcnt vmcnt(18)
    s_barrier
    ds_read_b64_tr_b16 v[24:25], v5 offset:0
    ds_read_b64_tr_b16 v[26:27], v5 offset:1024
    ds_read_b64_tr_b16 v[28:29], v6 offset:0
    ds_read_b64_tr_b16 v[30:31], v6 offset:1024
    ds_read_b64_tr_b16 v[32:33], v5 offset:2048
    ds_read_b64_tr_b16 v[34:35], v5 offset:3072
    ds_read_b64_tr_b16 v[36:37], v6 offset:2048
    ds_read_b64_tr_b16 v[38:39], v6 offset:3072
    ds_read_b64_tr_b16 v[40:41], v5 offset:4096
    ds_read_b64_tr_b16 v[42:43], v5 offset:5120
    s_waitcnt vmcnt(17) lgkmcnt(8)
    v_mfma_f32_32x32x16_bf16 v[112:127], v[24:27], v[160:163], 0
    ds_read_b64_tr_b16 v[44:45], v6 offset:4096
    ds_read_b64_tr_b16 v[46:47], v6 offset:5120
    buffer_load_dword v15, v8, s[12:15], s46 offen sc1
    s_waitcnt lgkmcnt(8)
    v_mfma_f32_32x32x16_bf16 v[128:143], v[28:31], v[160:163], 0
    ds_read_b64_tr_b16 v[24:25], v5 offset:6144
    ds_read_b64_tr_b16 v[26:27], v5 offset:7168
    buffer_load_dwordx4 v[48:51], v9, s[12:15], s44 offen offset:0 sc1
    s_waitcnt vmcnt(18) lgkmcnt(8)
    v_mfma_f32_32x32x16_bf16 v[112:127], v[32:35], v[164:167], v[112:127]
    ds_read_b64_tr_b16 v[28:29], v6 offset:6144
    ds_read_b64_tr_b16 v[30:31], v6 offset:7168
    buffer_load_dwordx4 v[52:55], v9, s[12:15], s44 offen offset:1024 sc1
    s_add_u32 s44, s44, 2359296
    s_waitcnt lgkmcnt(8)
    v_mfma_f32_32x32x16_bf16 v[128:143], v[36:39], v[164:167], v[128:143]
    ds_read_b64_tr_b16 v[32:33], v5 offset:8192
    ds_read_b64_tr_b16 v[34:35], v5 offset:9216
    buffer_load_dwordx4 v[56:59], v9, s[12:15], s44 offen offset:0 sc1
    s_waitcnt vmcnt(19) lgkmcnt(8)
    v_mfma_f32_32x32x16_bf16 v[112:127], v[40:43], v[168:171], v[112:127]
    ds_read_b64_tr_b16 v[36:37], v6 offset:8192
    ds_read_b64_tr_b16 v[38:39], v6 offset:9216
    buffer_load_dwordx4 v[60:63], v9, s[12:15], s44 offen offset:1024 sc1
    s_add_u32 s44, s44, 2359296
    s_waitcnt lgkmcnt(8)
    v_mfma_f32_32x32x16_bf16 v[128:143], v[44:47], v[168:171], v[128:143]
    ds_read_b64_tr_b16 v[40:41], v5 offset:10240
    ds_read_b64_tr_b16 v[42:43], v5 offset:11264
    buffer_load_dwordx4 v[64:67], v9, s[12:15], s44 offen offset:0 sc1
    s_waitcnt vmcnt(20) lgkmcnt(8)
    v_mfma_f32_32x32x16_bf16 v[112:127], v[24:27], v[172:175], v[112:127]
    ds_read_b64_tr_b16 v[44:45], v6 offset:10240
    ds_read_b64_tr_b16 v[46:47], v6 offset:11264
    buffer_load_dwordx4 v[68:71], v9, s[12:15], s44 offen offset:1024 sc1
    s_add_u32 s44, s44, 2359296
    s_waitcnt lgkmcnt(8)
    v_mfma_f32_32x32x16_bf16 v[128:143], v[28:31], v[172:175], v[128:143]
    ds_read_b64_tr_b16 v[24:25], v5 offset:12288
    ds_read_b64_tr_b16 v[26:27], v5 offset:13312
    buffer_load_dwordx4 v[72:75], v9, s[12:15], s44 offen offset:0 sc1
    s_waitcnt vmcnt(21) lgkmcnt(8)
    v_mfma_f32_32x32x16_bf16 v[112:127], v[32:35], v[176:179], v[112:127]
    ds_read_b64_tr_b16 v[28:29], v6 offset:12288
    ds_read_b64_tr_b16 v[30:31], v6 offset:13312
    buffer_load_dwordx4 v[76:79], v9, s[12:15], s44 offen offset:1024 sc1
    s_add_u32 s44, s44, 2359296
    s_waitcnt lgkmcnt(8)
    v_mfma_f32_32x32x16_bf16 v[128:143], v[36:39], v[176:179], v[128:143]
    ds_read_b64_tr_b16 v[32:33], v5 offset:14336
    ds_read_b64_tr_b16 v[34:35], v5 offset:15360
    buffer_load_dwordx4 v[80:83], v9, s[12:15], s45 offen offset:0 sc1
    s_waitcnt vmcnt(22) lgkmcnt(8)
    v_mfma_f32_32x32x16_bf16 v[112:127], v[40:43], v[180:183], v[112:127]
    ds_read_b64_tr_b16 v[36:37], v6 offset:14336
    ds_read_b64_tr_b16 v[38:39], v6 offset:15360
    buffer_load_dwordx4 v[84:87], v9, s[12:15], s45 offen offset:1024 sc1
    s_add_u32 s45, s45, 2359296
    s_waitcnt lgkmcnt(8)
    v_mfma_f32_32x32x16_bf16 v[128:143], v[44:47], v[180:183], v[128:143]
    ds_read_b64_tr_b16 v[40:41], v5 offset:16384
    ds_read_b64_tr_b16 v[42:43], v5 offset:17408
    buffer_load_dwordx4 v[88:91], v9, s[12:15], s45 offen offset:0 sc1
    s_waitcnt vmcnt(23) lgkmcnt(8)
    v_mfma_f32_32x32x16_bf16 v[112:127], v[24:27], v[184:187], v[112:127]
    ds_read_b64_tr_b16 v[44:45], v6 offset:16384
    ds_read_b64_tr_b16 v[46:47], v6 offset:17408
    buffer_load_dwordx4 v[92:95], v9, s[12:15], s45 offen offset:1024 sc1
    s_add_u32 s45, s45, 2359296
    s_waitcnt lgkmcnt(8)
    v_mfma_f32_32x32x16_bf16 v[128:143], v[28:31], v[184:187], v[128:143]
    ds_read_b64_tr_b16 v[24:25], v5 offset:18432
    ds_read_b64_tr_b16 v[26:27], v5 offset:19456
    buffer_load_dwordx4 v[96:99], v9, s[12:15], s45 offen offset:0 sc1
    s_waitcnt vmcnt(24) lgkmcnt(8)
    v_mfma_f32_32x32x16_bf16 v[112:127], v[32:35], v[188:191], v[112:127]
    ds_read_b64_tr_b16 v[28:29], v6 offset:18432
    ds_read_b64_tr_b16 v[30:31], v6 offset:19456
    buffer_load_dwordx4 v[100:103], v9, s[12:15], s45 offen offset:1024 sc1
    s_add_u32 s45, s45, 2359296
    s_waitcnt lgkmcnt(8)
    v_mfma_f32_32x32x16_bf16 v[128:143], v[36:39], v[188:191], v[128:143]
    ds_read_b64_tr_b16 v[32:33], v5 offset:20480
    ds_read_b64_tr_b16 v[34:35], v5 offset:21504
    buffer_load_dwordx4 v[104:107], v9, s[12:15], s45 offen offset:0 sc1
    s_waitcnt vmcnt(25) lgkmcnt(8)
    v_mfma_f32_32x32x16_bf16 v[112:127], v[40:43], v[192:195], v[112:127]
    ds_read_b64_tr_b16 v[36:37], v6 offset:20480
    ds_read_b64_tr_b16 v[38:39], v6 offset:21504
    buffer_load_dwordx4 v[108:111], v9, s[12:15], s45 offen offset:1024 sc1
    s_add_u32 s45, s45, 2359296
    s_waitcnt lgkmcnt(8)
    v_mfma_f32_32x32x16_bf16 v[128:143], v[44:47], v[192:195], v[128:143]
    ds_read_b64_tr_b16 v[40:41], v5 offset:22528
    ds_read_b64_tr_b16 v[42:43], v5 offset:23552
    s_waitcnt vmcnt(25) lgkmcnt(8)
    v_mfma_f32_32x32x16_bf16 v[112:127], v[24:27], v[196:199], v[112:127]
    ds_read_b64_tr_b16 v[44:45], v6 offset:22528
    ds_read_b64_tr_b16 v[46:47], v6 offset:23552
    s_waitcnt lgkmcnt(8)
    v_mfma_f32_32x32x16_bf16 v[128:143], v[28:31], v[196:199], v[128:143]
    ds_read_b64_tr_b16 v[24:25], v5 offset:24576
    ds_read_b64_tr_b16 v[26:27], v5 offset:25600
    s_waitcnt vmcnt(24) lgkmcnt(8)
    v_mfma_f32_32x32x16_bf16 v[112:127], v[32:35], v[200:203], v[112:127]
    ds_read_b64_tr_b16 v[28:29], v6 offset:24576
    ds_read_b64_tr_b16 v[30:31], v6 offset:25600
    s_waitcnt lgkmcnt(8)
    v_mfma_f32_32x32x16_bf16 v[128:143], v[36:39], v[200:203], v[128:143]
    ds_read_b64_tr_b16 v[32:33], v5 offset:26624
    ds_read_b64_tr_b16 v[34:35], v5 offset:27648
    s_waitcnt vmcnt(23) lgkmcnt(8)
    v_mfma_f32_32x32x16_bf16 v[112:127], v[40:43], v[204:207], v[112:127]
    ds_read_b64_tr_b16 v[36:37], v6 offset:26624
    ds_read_b64_tr_b16 v[38:39], v6 offset:27648
    s_waitcnt lgkmcnt(8)
    v_mfma_f32_32x32x16_bf16 v[128:143], v[44:47], v[204:207], v[128:143]
    ds_read_b64_tr_b16 v[40:41], v5 offset:28672
    ds_read_b64_tr_b16 v[42:43], v5 offset:29696
    s_waitcnt vmcnt(22) lgkmcnt(8)
    v_mfma_f32_32x32x16_bf16 v[112:127], v[24:27], v[208:211], v[112:127]
    ds_read_b64_tr_b16 v[44:45], v6 offset:28672
    ds_read_b64_tr_b16 v[46:47], v6 offset:29696
    s_waitcnt lgkmcnt(8)
    v_mfma_f32_32x32x16_bf16 v[128:143], v[28:31], v[208:211], v[128:143]
    ds_read_b64_tr_b16 v[24:25], v5 offset:30720
    ds_read_b64_tr_b16 v[26:27], v5 offset:31744
    s_waitcnt vmcnt(21) lgkmcnt(8)
    v_mfma_f32_32x32x16_bf16 v[112:127], v[32:35], v[212:215], v[112:127]
    ds_read_b64_tr_b16 v[28:29], v6 offset:30720
    ds_read_b64_tr_b16 v[30:31], v6 offset:31744
    s_waitcnt lgkmcnt(8)
    v_mfma_f32_32x32x16_bf16 v[128:143], v[36:39], v[212:215], v[128:143]
    ds_read_b64_tr_b16 v[32:33], v5 offset:32768
    ds_read_b64_tr_b16 v[34:35], v5 offset:33792
    s_waitcnt vmcnt(20) lgkmcnt(8)
    v_mfma_f32_32x32x16_bf16 v[112:127], v[40:43], v[216:219], v[112:127]
    ds_read_b64_tr_b16 v[36:37], v6 offset:32768
    ds_read_b64_tr_b16 v[38:39], v6 offset:33792
    s_waitcnt lgkmcnt(8)
    v_mfma_f32_32x32x16_bf16 v[128:143], v[44:47], v[216:219], v[128:143]
    ds_read_b64_tr_b16 v[40:41], v5 offset:34816
    ds_read_b64_tr_b16 v[42:43], v5 offset:35840
    s_waitcnt vmcnt(19) lgkmcnt(8)
    v_mfma_f32_32x32x16_bf16 v[112:127], v[24:27], v[220:223], v[112:127]
    ds_read_b64_tr_b16 v[44:45], v6 offset:34816
    ds_read_b64_tr_b16 v[46:47], v6 offset:35840
    s_waitcnt lgkmcnt(8)
    v_mfma_f32_32x32x16_bf16 v[128:143], v[28:31], v[220:223], v[128:143]
    s_waitcnt vmcnt(18) lgkmcnt(6)
    v_mfma_f32_32x32x16_bf16 v[112:127], v[32:35], v[224:227], v[112:127]
    s_waitcnt lgkmcnt(4)
    v_mfma_f32_32x32x16_bf16 v[128:143], v[36:39], v[224:227], v[128:143]
    s_waitcnt vmcnt(17) lgkmcnt(2)
    v_mfma_f32_32x32x16_bf16 v[112:127], v[40:43], v[228:231], v[112:127]
    s_waitcnt lgkmcnt(0)
    v_mfma_f32_32x32x16_bf16 v[128:143], v[44:47], v[228:231], v[128:143]
    s_cmp_eq_u32 s50, 0
    s_cbranch_scc1 k3_nxm0
    ds_read_b64_tr_b16 v[24:25], v7 offset:0
    ds_read_b64_tr_b16 v[26:27], v7 offset:512
    ds_read_b64_tr_b16 v[28:29], v7 offset:1024
    ds_read_b64_tr_b16 v[30:31], v7 offset:1536
    ds_read_b64_tr_b16 v[32:33], v7 offset:2048
    ds_read_b64_tr_b16 v[34:35], v7 offset:2560
    ds_read_b64_tr_b16 v[36:37], v7 offset:3072
    ds_read_b64_tr_b16 v[38:39], v7 offset:3584
    ds_read_b64_tr_b16 v[40:41], v7 offset:4096
    ds_read_b64_tr_b16 v[42:43], v7 offset:4608
    s_waitcnt lgkmcnt(8)
    v_mfma_f32_32x32x16_bf16 v[144:159], v[24:27], v[160:163], 0
    ds_read_b64_tr_b16 v[44:45], v7 offset:5120
    ds_read_b64_tr_b16 v[46:47], v7 offset:5632
    s_waitcnt lgkmcnt(8)
    v_mfma_f32_32x32x16_bf16 v[144:159], v[28:31], v[164:167], v[144:159]
    ds_read_b64_tr_b16 v[24:25], v7 offset:6144
    ds_read_b64_tr_b16 v[26:27], v7 offset:6656
    s_waitcnt lgkmcnt(8)
    v_mfma_f32_32x32x16_bf16 v[144:159], v[32:35], v[168:171], v[144:159]
    ds_read_b64_tr_b16 v[28:29], v7 offset:7168
    ds_read_b64_tr_b16 v[30:31], v7 offset:7680
    s_waitcnt lgkmcnt(8)
    v_mfma_f32_32x32x16_bf16 v[144:159], v[36:39], v[172:175], v[144:159]
    ds_read_b64_tr_b16 v[32:33], v7 offset:8192
    ds_read_b64_tr_b16 v[34:35], v7 offset:8704
    s_waitcnt lgkmcnt(8)
    v_mfma_f32_32x32x16_bf16 v[144:159], v[40:43], v[176:179], v[144:159]
    ds_read_b64_tr_b16 v[36:37], v7 offset:9216
    ds_read_b64_tr_b16 v[38:39], v7 offset:9728
    s_waitcnt lgkmcnt(8)
    v_mfma_f32_32x32x16_bf16 v[144:159], v[44:47], v[180:183], v[144:159]
    ds_read_b64_tr_b16 v[40:41], v7 offset:10240
    ds_read_b64_tr_b16 v[42:43], v7 offset:10752
    s_waitcnt lgkmcnt(8)
    v_mfma_f32_32x32x16_bf16 v[144:159], v[24:27], v[184:187], v[144:159]
    ds_read_b64_tr_b16 v[44:45], v7 offset:11264
    ds_read_b64_tr_b16 v[46:47], v7 offset:11776
    s_waitcnt lgkmcnt(8)
    v_mfma_f32_32x32x16_bf16 v[144:159], v[28:31], v[188:191], v[144:159]
    ds_read_b64_tr_b16 v[24:25], v7 offset:12288
    ds_read_b64_tr_b16 v[26:27], v7 offset:12800
    s_waitcnt lgkmcnt(8)
    v_mfma_f32_32x32x16_bf16 v[144:159], v[32:35], v[192:195], v[144:159]
    ds_read_b64_tr_b16 v[28:29], v7 offset:13312
    ds_read_b64_tr_b16 v[30:31], v7 offset:13824
    s_waitcnt lgkmcnt(8)
    v_mfma_f32_32x32x16_bf16 v[144:159], v[36:39], v[196:199], v[144:159]
    ds_read_b64_tr_b16 v[32:33], v7 offset:14336
    ds_read_b64_tr_b16 v[34:35], v7 offset:14848
    s_waitcnt lgkmcnt(8)
    v_mfma_f32_32x32x16_bf16 v[144:159], v[40:43], v[200:203], v[144:159]
    ds_read_b64_tr_b16 v[36:37], v7 offset:15360
    ds_read_b64_tr_b16 v[38:39], v7 offset:15872
    s_waitcnt lgkmcnt(8)
    v_mfma_f32_32x32x16_bf16 v[144:159], v[44:47], v[204:207], v[144:159]
    ds_read_b64_tr_b16 v[40:41], v7 offset:16384
    ds_read_b64_tr_b16 v[42:43], v7 offset:16896
    s_waitcnt lgkmcnt(8)
    v_mfma_f32_32x32x16_bf16 v[144:159], v[24:27], v[208:211], v[144:159]
    ds_read_b64_tr_b16 v[44:45], v7 offset:17408
    ds_read_b64_tr_b16 v[46:47], v7 offset:17920
    s_waitcnt lgkmcnt(8)
    v_mfma_f32_32x32x16_bf16 v[144:159], v[28:31], v[212:215], v[144:159]
    s_waitcnt lgkmcnt(6)
    v_mfma_f32_32x32x16_bf16 v[144:159], v[32:35], v[216:219], v[144:159]
    s_waitcnt lgkmcnt(4)
    v_mfma_f32_32x32x16_bf16 v[144:159], v[36:39], v[220:223], v[144:159]
    s_waitcnt lgkmcnt(2)
    v_mfma_f32_32x32x16_bf16 v[144:159], v[40:43], v[224:227], v[144:159]
    s_waitcnt lgkmcnt(0)
    v_mfma_f32_32x32x16_bf16 v[144:159], v[44:47], v[228:231], v[144:159]
k3_nxm0:
    s_waitcnt vmcnt(0)
    v_mfma_f32_32x32x16_bf16 v[160:175], v[16:19], v[48:51], 0
    v_mfma_f32_32x32x16_bf16 v[160:175], v[20:23], v[52:55], v[160:175]
    v_mfma_f32_32x32x16_bf16 v[160:175], v[16:19], v[56:59], v[160:175]
    v_mfma_f32_32x32x16_bf16 v[160:175], v[20:23], v[60:63], v[160:175]
    v_mfma_f32_32x32x16_bf16 v[160:175], v[16:19], v[64:67], v[160:175]
    v_mfma_f32_32x32x16_bf16 v[160:175], v[20:23], v[68:71], v[160:175]
    v_mfma_f32_32x32x16_bf16 v[160:175], v[16:19], v[72:75], v[160:175]
    v_mfma_f32_32x32x16_bf16 v[160:175], v[20:23], v[76:79], v[160:175]
    s_cmp_eq_u32 s48, 0
    s_cselect_b64 vcc, -1, 0
    v_cndmask_b32 v10, 0, v15, vcc
    v_cndmask_b32 v11, v15, 0, vcc
    s_cmp_eq_u32 s50, 0
    s_cbranch_scc1 k3_nxm1
    v_mfma_f32_32x32x16_bf16 v[176:191], v[16:19], v[80:83], 0
    v_mfma_f32_32x32x16_bf16 v[176:191], v[20:23], v[84:87], v[176:191]
    v_mfma_f32_32x32x16_bf16 v[176:191], v[16:19], v[88:91], v[176:191]
    v_mfma_f32_32x32x16_bf16 v[176:191], v[20:23], v[92:95], v[176:191]
    v_mfma_f32_32x32x16_bf16 v[176:191], v[16:19], v[96:99], v[176:191]
    v_mfma_f32_32x32x16_bf16 v[176:191], v[20:23], v[100:103], v[176:191]
    v_mfma_f32_32x32x16_bf16 v[176:191], v[16:19], v[104:107], v[176:191]
    v_mfma_f32_32x32x16_bf16 v[176:191], v[20:23], v[108:111], v[176:191]
k3_nxm1:
    s_nop 5
    v_fmac_f32 v112, v160, v10
    v_fmac_f32 v113, v161, v10
    v_fmac_f32 v114, v162, v10
    v_fmac_f32 v115, v163, v10
    v_fmac_f32 v116, v164, v10
    v_fmac_f32 v117, v165, v10
    v_fmac_f32 v118, v166, v10
    v_fmac_f32 v119, v167, v10
    v_fmac_f32 v120, v168, v10
    v_fmac_f32 v121, v169, v10
    v_fmac_f32 v122, v170, v10
    v_fmac_f32 v123, v171, v10
    v_fmac_f32 v124, v172, v10
    v_fmac_f32 v125, v173, v10
    v_fmac_f32 v126, v174, v10
    v_fmac_f32 v127, v175, v10
    v_fmac_f32 v128, v160, v11
    v_fmac_f32 v129, v161, v11
    v_fmac_f32 v130, v162, v11
    v_fmac_f32 v131, v163, v11
    v_fmac_f32 v132, v164, v11
    v_fmac_f32 v133, v165, v11
    v_fmac_f32 v134, v166, v11
    v_fmac_f32 v135, v167, v11
    v_fmac_f32 v136, v168, v11
    v_fmac_f32 v137, v169, v11
    v_fmac_f32 v138, v170, v11
    v_fmac_f32 v139, v171, v11
    v_fmac_f32 v140, v172, v11
    v_fmac_f32 v141, v173, v11
    v_fmac_f32 v142, v174, v11
    v_fmac_f32 v143, v175, v11
    s_cmp_eq_u32 s50, 0
    s_cbranch_scc1 k3_nxm
    v_fmac_f32 v144, v176, v15
    v_fmac_f32 v145, v177, v15
    v_fmac_f32 v146, v178, v15
    v_fmac_f32 v147, v179, v15
    v_fmac_f32 v148, v180, v15
    v_fmac_f32 v149, v181, v15
    v_fmac_f32 v150, v182, v15
    v_fmac_f32 v151, v183, v15
    v_fmac_f32 v152, v184, v15
    v_fmac_f32 v153, v185, v15
    v_fmac_f32 v154, v186, v15
    v_fmac_f32 v155, v187, v15
    v_fmac_f32 v156, v188, v15
    v_fmac_f32 v157, v189, v15
    v_fmac_f32 v158, v190, v15
    v_fmac_f32 v159, v191, v15
k3_nxm:
    v_and_b32 v10, 31, v1
    v_mul_u32_u24 v10, 400, v10
    v_lshrrev_b32 v11, 5, v1
    v_lshl_add_u32 v10, v11, 4, v10
    s_mul_i32 s60, s48, 25600
    s_lshr_b32 s62, s40, 1
    s_mul_i32 s62, s62, 12800
    s_add_u32 s60, s60, s62
    v_add_u32 v10, s60, v10
    v_lshrrev_b32 v11, 3, v1
    v_mul_u32_u24 v11, 400, v11
    v_lshl_add_u32 v11, v253, 1, v11
    s_mul_i32 s60, s40, 6400
    v_add_u32 v11, s60, v11
    v_bfe_u32 v12, v1, 2, 3
    v_mul_u32_u24 v12, 400, v12
    v_lshl_add_u32 v12, v255, 1, v12
    s_bfe_u32 s60, s41, 0x10001
    s_lshl_b32 s60, s60, 2
    s_add_u32 s60, s60, s40
    s_mul_i32 s60, s60, 3200
    s_add_u32 s60, s60, 256
    v_add_u32 v12, s60, v12
    s_barrier
    ds_write_b128 v10, v[112:115] offset:0
    ds_write_b128 v10, v[116:119] offset:32
    ds_write_b128 v10, v[120:123] offset:64
    ds_write_b128 v10, v[124:127] offset:96
    ds_write_b128 v10, v[128:131] offset:128
    ds_write_b128 v10, v[132:135] offset:160
    ds_write_b128 v10, v[136:139] offset:192
    ds_write_b128 v10, v[140:143] offset:224
    s_cmp_eq_u32 s50, 0
    s_cbranch_scc1 k3_nxw
    ds_write_b128 v10, v[144:147] offset:256
    ds_write_b128 v10, v[148:151] offset:288
    ds_write_b128 v10, v[152:155] offset:320
    ds_write_b128 v10, v[156:159] offset:352
k3_nxw:
    s_waitcnt lgkmcnt(0)
    s_barrier
    ds_read_b128 v[32:35], v11 offset:0
    ds_read_b128 v[36:39], v11 offset:16
    ds_read_b128 v[40:43], v11 offset:25600
    ds_read_b128 v[44:47], v11 offset:25616
    ds_read_b128 v[48:51], v11 offset:3200
    ds_read_b128 v[52:55], v11 offset:3216
    ds_read_b128 v[56:59], v11 offset:28800
    ds_read_b128 v[60:63], v11 offset:28816
    ds_read_b128 v[96:99], v12 offset:0
    ds_read_b128 v[100:103], v12 offset:16
    ds_read_b128 v[104:107], v12 offset:25600
    ds_read_b128 v[108:111], v12 offset:25616
    s_waitcnt vmcnt(0)
    v_lshlrev_b32 v64, 16, v240
    v_and_b32 v65, 0xffff0000, v240
    v_lshlrev_b32 v72, 16, v232
    v_and_b32 v73, 0xffff0000, v232
    v_lshlrev_b32 v66, 16, v241
    v_and_b32 v67, 0xffff0000, v241
    v_lshlrev_b32 v74, 16, v233
    v_and_b32 v75, 0xffff0000, v233
    v_lshlrev_b32 v68, 16, v242
    v_and_b32 v69, 0xffff0000, v242
    v_lshlrev_b32 v76, 16, v234
    v_and_b32 v77, 0xffff0000, v234
    v_lshlrev_b32 v70, 16, v243
    v_and_b32 v71, 0xffff0000, v243
    v_lshlrev_b32 v78, 16, v235
    v_and_b32 v79, 0xffff0000, v235
    v_add_f32 v72, v72, v64
    v_add_f32 v73, v73, v65
    v_add_f32 v74, v74, v66
    v_add_f32 v75, v75, v67
    v_add_f32 v76, v76, v68
    v_add_f32 v77, v77, v69
    v_add_f32 v78, v78, v70
    v_add_f32 v79, v79, v71
    s_waitcnt lgkmcnt(8)
    v_add_f32 v32, v32, v40
    v_add_f32 v33, v33, v41
    v_add_f32 v34, v34, v42
    v_add_f32 v35, v35, v43
    v_add_f32 v36, v36, v44
    v_add_f32 v37, v37, v45
    v_add_f32 v38, v38, v46
    v_add_f32 v39, v39, v47
    v_add_f32 v72, v72, v32
    v_add_f32 v73, v73, v33
    v_add_f32 v74, v74, v34
    v_add_f32 v75, v75, v35
    v_add_f32 v76, v76, v36
    v_add_f32 v77, v77, v37
    v_add_f32 v78, v78, v38
    v_add_f32 v79, v79, v39
    v_cvt_pk_bf16_f32 v80, v72, v73
    v_cvt_pk_bf16_f32 v81, v74, v75
    v_cvt_pk_bf16_f32 v82, v76, v77
    v_cvt_pk_bf16_f32 v83, v78, v79
    buffer_store_dwordx4 v[80:83], v252, s[20:23], s56 offen
    v_lshlrev_b32 v64, 16, v240
    v_and_b32 v65, 0xffff0000, v240
    v_lshlrev_b32 v72, 16, v236
    v_and_b32 v73, 0xffff0000, v236
    v_lshlrev_b32 v66, 16, v241
    v_and_b32 v67, 0xffff0000, v241
    v_lshlrev_b32 v74, 16, v237
    v_and_b32 v75, 0xffff0000, v237
    v_lshlrev_b32 v68, 16, v242
    v_and_b32 v69, 0xffff0000, v242
    v_lshlrev_b32 v76, 16, v238
    v_and_b32 v77, 0xffff0000, v238
    v_lshlrev_b32 v70, 16, v243
    v_and_b32 v71, 0xffff0000, v243
    v_lshlrev_b32 v78, 16, v239
    v_and_b32 v79, 0xffff0000, v239
    v_add_f32 v72, v72, v64
    v_add_f32 v73, v73, v65
    v_add_f32 v74, v74, v66
    v_add_f32 v75, v75, v67
    v_add_f32 v76, v76, v68
    v_add_f32 v77, v77, v69
    v_add_f32 v78, v78, v70
    v_add_f32 v79, v79, v71
    s_waitcnt lgkmcnt(4)
    v_add_f32 v48, v48, v56
    v_add_f32 v49, v49, v57
    v_add_f32 v50, v50, v58
    v_add_f32 v51, v51, v59
    v_add_f32 v52, v52, v60
    v_add_f32 v53, v53, v61
    v_add_f32 v54, v54, v62
    v_add_f32 v55, v55, v63
    v_add_f32 v72, v72, v48
    v_add_f32 v73, v73, v49
    v_add_f32 v74, v74, v50
    v_add_f32 v75, v75, v51
    v_add_f32 v76, v76, v52
    v_add_f32 v77, v77, v53
    v_add_f32 v78, v78, v54
    v_add_f32 v79, v79, v55
    v_cvt_pk_bf16_f32 v84, v72, v73
    v_cvt_pk_bf16_f32 v85, v74, v75
    v_cvt_pk_bf16_f32 v86, v76, v77
    v_cvt_pk_bf16_f32 v87, v78, v79
    buffer_store_dwordx4 v[84:87], v252, s[20:23], s57 offen
    s_cmp_ge_u32 s41, 4
    s_cbranch_scc1 k3_fin
    v_lshlrev_b32 v64, 16, v248
    v_and_b32 v65, 0xffff0000, v248
    v_lshlrev_b32 v72, 16, v244
    v_and_b32 v73, 0xffff0000, v244
    v_lshlrev_b32 v66, 16, v249
    v_and_b32 v67, 0xffff0000, v249
    v_lshlrev_b32 v74, 16, v245
    v_and_b32 v75, 0xffff0000, v245
    v_lshlrev_b32 v68, 16, v250
    v_and_b32 v69, 0xffff0000, v250
    v_lshlrev_b32 v76, 16, v246
    v_and_b32 v77, 0xffff0000, v246
    v_lshlrev_b32 v70, 16, v251
    v_and_b32 v71, 0xffff0000, v251
    v_lshlrev_b32 v78, 16, v247
    v_and_b32 v79, 0xffff0000, v247
    v_add_f32 v72, v72, v64
    v_add_f32 v73, v73, v65
    v_add_f32 v74, v74, v66
    v_add_f32 v75, v75, v67
    v_add_f32 v76, v76, v68
    v_add_f32 v77, v77, v69
    v_add_f32 v78, v78, v70
    v_add_f32 v79, v79, v71
    s_waitcnt lgkmcnt(0)
    v_add_f32 v96, v96, v104
    v_add_f32 v97, v97, v105
    v_add_f32 v98, v98, v106
    v_add_f32 v99, v99, v107
    v_add_f32 v100, v100, v108
    v_add_f32 v101, v101, v109
    v_add_f32 v102, v102, v110
    v_add_f32 v103, v103, v111
    v_add_f32 v72, v72, v96
    v_add_f32 v73, v73, v97
    v_add_f32 v74, v74, v98
    v_add_f32 v75, v75, v99
    v_add_f32 v76, v76, v100
    v_add_f32 v77, v77, v101
    v_add_f32 v78, v78, v102
    v_add_f32 v79, v79, v103
    v_cvt_pk_bf16_f32 v88, v72, v73
    v_cvt_pk_bf16_f32 v89, v74, v75
    v_cvt_pk_bf16_f32 v90, v76, v77
    v_cvt_pk_bf16_f32 v91, v78, v79
    v_cmp_gt_u32 vcc, 32, v1
    s_and_saveexec_b64 s[96:97], vcc
    buffer_store_dwordx4 v[88:91], v4, s[20:23], s58 offen
k3_fin:
    s_endpgm
g_sw2:
    s_mov_b32 s8, s34
    s_mov_b32 s9, s35
    s_mov_b32 s10, 5308416
    s_mov_b32 s11, 0x00020000
    s_lshl_b32 s60, s59, 1
    s_and_b32 s61, s42, 1
    s_add_u32 s60, s60, s61
    s_mov_b32 s101, 5517840
    s_cmp_eq_u32 s60, 1
    s_cselect_b32 s101, 4534560, s101
    s_cmp_eq_u32 s60, 2
    s_cselect_b32 s101, 5517345, s101
    s_cmp_eq_u32 s60, 3
    s_cselect_b32 s101, 4534785, s101
    s_cmp_eq_u32 s60, 4
    s_cselect_b32 s101, 4399365, s101
    s_cmp_eq_u32 s60, 5
    s_cselect_b32 s101, 4391445, s101
    s_cmp_eq_u32 s60, 6
    s_cselect_b32 s101, 5517570, s101
    s_cmp_eq_u32 s60, 7
    s_cselect_b32 s101, 4534290, s101
    s_mov_b32 s49, 1152
    v_lshrrev_b32 v34, 3, v1
    v_and_b32 v35, 7, v1
    v_bfe_u32 v0, v1, 4, 1
    v_lshlrev_b32 v0, 2, v0
    v_xor_b32 v35, v35, v0
    v_mul_lo_u32 v34, v34, s49
    v_lshl_add_u32 v2, v35, 4, v34
    s_lshl_b32 s60, s49, 3
    s_sub_u32 s60, s60, 1024
    v_add_u32 v3, s60, v2
    v_add_u32 v4, s60, v3
    s_mul_i32 s53, s49, 192
    s_mul_i32 s54, s49, 24
    s_mul_i32 s95, s92, s53
    s_mul_i32 s96, s93, s53
    s_mul_i32 s97, s94, s53
    s_mul_i32 s60, s38, 1152
    s_mul_i32 s61, s40, 48
    s_add_u32 s60, s60, s61
    s_mul_i32 s56, s60, 1152
    s_lshl_b32 s89, s59, 8
    s_and_b32 s64, s59, 1
    s_lshl_b32 s64, s64, 6
    s_add_u32 s64, s64, 1024
    s_cmp_lt_u32 s59, 2
    s_cselect_b32 s58, 7, 56
    s_and_b32 s60, s41, 11
    s_cmp_eq_u32 s60, 0
    s_cselect_b32 s58, 63, s58
    s_cmp_eq_u32 s60, 2
    s_cselect_b32 s58, 0, s58
    s_mov_b32 s45, s56
    s_and_b32 s60, s101, 15
    s_mul_i32 s60, s60, 221184
    s_lshr_b32 s100, s101, 4
    s_and_b32 s61, s100, 15
    s_mul_i32 s61, s61, 221184
    s_add_u32 s86, s56, s61
    s_add_u32 s95, s89, s60
    s_add_u32 s65, s95, 128
    s_add_u32 s62, s89, s61
    s_add_u32 s64, s64, s60
    s_and_b32 s60, s100, 15
    s_bitcmp1_b32 s58, s60
    s_cselect_b32 s61, 1, 2
    s_and_b32 s60, s101, 15
    s_bitcmp1_b32 s58, s60
    s_cselect_b32 s96, s64, s65
    s_cselect_b32 s97, s65, s62
    s_cselect_b32 s87, 0, s61
    s_mov_b32 s88, 1
    s_mov_b32 s51, 2147418112
    s_cmp_eq_u32 s99, 0
    s_cbranch_scc1 g_sw2_ret0
    s_branch g_sw2_ret1
g_kvd0:
    v_lshrrev_b32 v28, 3, v1
    v_mul_u32_u24 v28, 36, v28
    v_and_b32 v29, 3, v1
    v_lshl_add_u32 v2, v29, 4, v28
    v_bfe_u32 v28, v1, 2, 1
    v_bfe_u32 v29, v1, 4, 1
    v_cmp_eq_u32 s[98:99], v28, v29
    s_mul_i32 s60, s92, 192
    s_mul_i32 s61, s40, 48
    s_add_u32 s60, s60, s61
    s_mul_i32 s60, s60, 36
    s_mov_b32 s8, s28
    s_mov_b32 s9, s29
    s_mov_b32 s10, 20736
    s_mov_b32 s11, 0x00020000
    s_mov_b64 exec, s[98:99]
    s_add_u32 m0, s47, 0
    s_add_u32 s61, s60, 0
    buffer_load_dwordx4 v2, s[8:11], s61 offen lds
    s_add_u32 m0, s47, 1024
    s_add_u32 s61, s60, 288
    buffer_load_dwordx4 v2, s[8:11], s61 offen lds
    s_add_u32 m0, s47, 2048
    s_add_u32 s61, s60, 576
    buffer_load_dwordx4 v2, s[8:11], s61 offen lds
    s_add_u32 m0, s47, 3072
    s_add_u32 s61, s60, 864
    buffer_load_dwordx4 v2, s[8:11], s61 offen lds
    s_add_u32 m0, s47, 4096
    s_add_u32 s61, s60, 1152
    buffer_load_dwordx4 v2, s[8:11], s61 offen lds
    s_add_u32 m0, s47, 5120
    s_add_u32 s61, s60, 1440
    buffer_load_dwordx4 v2, s[8:11], s61 offen lds
    s_mov_b32 s8, s30
    s_mov_b32 s9, s31
    s_mov_b32 s10, 20736
    s_mov_b32 s11, 0x00020000
    s_not_b64 exec, s[98:99]
    s_add_u32 m0, s47, 0
    s_add_u32 s61, s60, 0
    buffer_load_dwordx4 v2, s[8:11], s61 offen lds
    s_add_u32 m0, s47, 1024
    s_add_u32 s61, s60, 288
    buffer_load_dwordx4 v2, s[8:11], s61 offen lds
    s_add_u32 m0, s47, 2048
    s_add_u32 s61, s60, 576
    buffer_load_dwordx4 v2, s[8:11], s61 offen lds
    s_add_u32 m0, s47, 3072
    s_add_u32 s61, s60, 864
    buffer_load_dwordx4 v2, s[8:11], s61 offen lds
    s_add_u32 m0, s47, 4096
    s_add_u32 s61, s60, 1152
    buffer_load_dwordx4 v2, s[8:11], s61 offen lds
    s_add_u32 m0, s47, 5120
    s_add_u32 s61, s60, 1440
    buffer_load_dwordx4 v2, s[8:11], s61 offen lds
    s_mov_b64 exec, -1
    s_add_u32 s47, s47, 24576
    s_branch g_kvd0_ret
g_kvd1:
    s_mul_i32 s60, s93, 192
    s_mul_i32 s61, s40, 48
    s_add_u32 s60, s60, s61
    s_mul_i32 s60, s60, 36
    s_mov_b32 s8, s28
    s_mov_b32 s9, s29
    s_mov_b32 s10, 20736
    s_mov_b32 s11, 0x00020000
    s_mov_b64 exec, s[98:99]
    s_add_u32 m0, s47, 0
    s_add_u32 s61, s60, 0
    buffer_load_dwordx4 v2, s[8:11], s61 offen lds
    s_add_u32 m0, s47, 1024
    s_add_u32 s61, s60, 288
    buffer_load_dwordx4 v2, s[8:11], s61 offen lds
    s_add_u32 m0, s47, 2048
    s_add_u32 s61, s60, 576
    buffer_load_dwordx4 v2, s[8:11], s61 offen lds
    s_add_u32 m0, s47, 3072
    s_add_u32 s61, s60, 864
    buffer_load_dwordx4 v2, s[8:11], s61 offen lds
    s_add_u32 m0, s47, 4096
    s_add_u32 s61, s60, 1152
    buffer_load_dwordx4 v2, s[8:11], s61 offen lds
    s_add_u32 m0, s47, 5120
    s_add_u32 s61, s60, 1440
    buffer_load_dwordx4 v2, s[8:11], s61 offen lds
    s_mov_b32 s8, s30
    s_mov_b32 s9, s31
    s_mov_b32 s10, 20736
    s_mov_b32 s11, 0x00020000
    s_not_b64 exec, s[98:99]
    s_add_u32 m0, s47, 0
    s_add_u32 s61, s60, 0
    buffer_load_dwordx4 v2, s[8:11], s61 offen lds
    s_add_u32 m0, s47, 1024
    s_add_u32 s61, s60, 288
    buffer_load_dwordx4 v2, s[8:11], s61 offen lds
    s_add_u32 m0, s47, 2048
    s_add_u32 s61, s60, 576
    buffer_load_dwordx4 v2, s[8:11], s61 offen lds
    s_add_u32 m0, s47, 3072
    s_add_u32 s61, s60, 864
    buffer_load_dwordx4 v2, s[8:11], s61 offen lds
    s_add_u32 m0, s47, 4096
    s_add_u32 s61, s60, 1152
    buffer_load_dwordx4 v2, s[8:11], s61 offen lds
    s_add_u32 m0, s47, 5120
    s_add_u32 s61, s60, 1440
    buffer_load_dwordx4 v2, s[8:11], s61 offen lds
    s_mov_b64 exec, -1
    s_add_u32 s47, s47, 24576
    s_branch g_kvd1_ret
g_kvd2:
    s_mul_i32 s60, s94, 192
    s_mul_i32 s61, s40, 48
    s_add_u32 s60, s60, s61
    s_mul_i32 s60, s60, 36
    s_mov_b32 s8, s28
    s_mov_b32 s9, s29
    s_mov_b32 s10, 20736
    s_mov_b32 s11, 0x00020000
    s_mov_b64 exec, s[98:99]
    s_add_u32 m0, s47, 0
    s_add_u32 s61, s60, 0
    buffer_load_dwordx4 v2, s[8:11], s61 offen lds
    s_add_u32 m0, s47, 1024
    s_add_u32 s61, s60, 288
    buffer_load_dwordx4 v2, s[8:11], s61 offen lds
    s_add_u32 m0, s47, 2048
    s_add_u32 s61, s60, 576
    buffer_load_dwordx4 v2, s[8:11], s61 offen lds
    s_add_u32 m0, s47, 3072
    s_add_u32 s61, s60, 864
    buffer_load_dwordx4 v2, s[8:11], s61 offen lds
    s_add_u32 m0, s47, 4096
    s_add_u32 s61, s60, 1152
    buffer_load_dwordx4 v2, s[8:11], s61 offen lds
    s_add_u32 m0, s47, 5120
    s_add_u32 s61, s60, 1440
    buffer_load_dwordx4 v2, s[8:11], s61 offen lds
    s_mov_b32 s8, s30
    s_mov_b32 s9, s31
    s_mov_b32 s10, 20736
    s_mov_b32 s11, 0x00020000
    s_not_b64 exec, s[98:99]
    s_add_u32 m0, s47, 0
    s_add_u32 s61, s60, 0
    buffer_load_dwordx4 v2, s[8:11], s61 offen lds
    s_add_u32 m0, s47, 1024
    s_add_u32 s61, s60, 288
    buffer_load_dwordx4 v2, s[8:11], s61 offen lds
    s_add_u32 m0, s47, 2048
    s_add_u32 s61, s60, 576
    buffer_load_dwordx4 v2, s[8:11], s61 offen lds
    s_add_u32 m0, s47, 3072
    s_add_u32 s61, s60, 864
    buffer_load_dwordx4 v2, s[8:11], s61 offen lds
    s_add_u32 m0, s47, 4096
    s_add_u32 s61, s60, 1152
    buffer_load_dwordx4 v2, s[8:11], s61 offen lds
    s_add_u32 m0, s47, 5120
    s_add_u32 s61, s60, 1440
    buffer_load_dwordx4 v2, s[8:11], s61 offen lds
    s_mov_b64 exec, -1
    s_add_u32 s47, s47, 24576
    s_branch g_kvd2_ret
g_epkv:
    s_mul_i32 s60, s43, 2368
    s_add_u32 s60, s60, 22020096
    v_mul_f32 v48, v48, v8
    v_mul_f32 v49, v49, v8
    v_mul_f32 v50, v50, v8
    v_mul_f32 v51, v51, v8
    v_mul_f32 v52, v52, v8
    v_mul_f32 v53, v53, v8
    v_mul_f32 v54, v54, v8
    v_mul_f32 v55, v55, v8
    v_mul_f32 v56, v56, v8
    v_mul_f32 v57, v57, v8
    v_cvt_pk_bf16_f32 v80, v48, v49
    v_cvt_pk_bf16_f32 v81, v50, v51
    v_cvt_pk_bf16_f32 v82, v52, v53
    v_cvt_pk_bf16_f32 v83, v54, v55
    v_cvt_pk_bf16_f32 v84, v56, v57
    v_mul_f32 v64, v64, v8
    v_mul_f32 v65, v65, v8
    v_mul_f32 v66, v66, v8
    v_mul_f32 v67, v67, v8
    v_mul_f32 v68, v68, v8
    v_mul_f32 v69, v69, v8
    v_mul_f32 v70, v70, v8
    v_mul_f32 v71, v71, v8
    v_mul_f32 v72, v72, v8
    v_mul_f32 v73, v73, v8
    v_cvt_pk_bf16_f32 v88, v64, v65
    v_cvt_pk_bf16_f32 v89, v66, v67
    v_cvt_pk_bf16_f32 v90, v68, v69
    v_cvt_pk_bf16_f32 v91, v70, v71
    v_cvt_pk_bf16_f32 v92, v72, v73
    buffer_store_dwordx4 v[80:83], v9, s[12:15], s60 offen sc1
    v_bfe_u32 v96, v1, 4, 1
    v_bfe_u32 v97, v1, 2, 1
    v_lshl_add_u32 v96, v96, 1, v97
    v_mul_u32_u24 v96, 304, v96
    v_bfe_u32 v97, v1, 3, 1
    v_and_b32 v98, 3, v1
    v_lshl_add_u32 v97, v97, 2, v98
    v_lshl_add_u32 v96, v97, 1, v96
    v_lshrrev_b32 v97, 5, v1
    v_lshl_add_u32 v96, v97, 6, v96
    s_lshl_b32 s61, s40, 11
    s_add_u32 s61, s61, 98304
    v_add_u32 v96, s61, v96
    ds_write_b16 v96, v88 offset:0
    ds_write_b16_d16_hi v96, v88 offset:16
    ds_write_b16 v96, v89 offset:32
    ds_write_b16_d16_hi v96, v89 offset:48
    ds_write_b16 v96, v90 offset:128
    ds_write_b16_d16_hi v96, v90 offset:144
    ds_write_b16 v96, v91 offset:160
    ds_write_b16_d16_hi v96, v91 offset:176
    v_mov_b32 v99, 0x3f80
    v_lshlrev_b32 v98, 2, v1
    s_mov_b32 exec_hi, 0
    buffer_store_dword v84, v98, s[12:15], s60 offen offset:1024 sc1
    ds_write_b16 v96, v92 offset:256
    ds_write_b16_d16_hi v96, v92 offset:272
    ds_write_b16 v96, v99 offset:288
    s_mov_b64 exec, -1
    v_add_u32 v97, s61, v9
    s_waitcnt lgkmcnt(0)
    ds_read_b128 v[100:103], v97
    ds_read_b128 v[104:107], v97 offset:1024
    s_waitcnt lgkmcnt(0)
    buffer_store_dwordx4 v[100:103], v9, s[12:15], s60 offen offset:1152 sc1
    s_mov_b64 exec, 0xfff
    buffer_store_dwordx4 v[104:107], v9, s[12:15], s60 offen offset:2176 sc1
    s_mov_b64 exec, -1
    s_branch g_ep_done
ka_a:
    s_cmp_ge_u32 s2, 32
    s_cbranch_scc1 ka_nocpf
    s_cmp_lg_u32 s39, 3
    s_cbranch_scc1 ka_nocpf
    s_getpc_b64 s[100:101]
ka_pc:
    s_sub_u32 s100, s100, ka_pc-parallel_sum__grouped_kv_mqa__dense_activation_squared_relu__prompt_kernel
    s_subb_u32 s101, s101, 0
    s_lshr_b32 s61, s2, 3
    s_lshl_b32 s61, s61, 13
    v_and_b32 v2, 63, v0
    v_lshlrev_b32 v2, 7, v2
    v_add_u32 v2, s61, v2
    v_min_u32 v2, all_code_end-parallel_sum__grouped_kv_mqa__dense_activation_squared_relu__prompt_kernel, v2
    global_load_dword v200, v2, s[100:101]
ka_nocpf:
    s_barrier
    v_and_b32 v1, 63, v0
    v_lshlrev_b32 v11, 4, v1
    s_mul_i32 s44, s39, 5120
    s_add_u32 s46, s44, 22020096
    s_add_u32 s47, s44, 98304
    v_mov_b32 v10, 729808896
    s_mov_b32 s62, s41
    s_lshl_b32 s43, s42, 2
    s_lshr_b32 s44, s41, 2
    s_add_u32 s43, s43, s44
    s_and_b32 s41, s41, 3
    s_lshl_b32 s41, s41, 3
    s_lshl_b32 s44, s39, 1
    s_add_u32 s41, s41, s44
    s_mul_i32 s48, s43, 331776
    v_lshrrev_b32 v2, 5, v1
    v_lshlrev_b32 v2, 2, v2
    v_and_b32 v9, 31, v1
    v_lshlrev_b32 v9, 4, v9
    s_mul_i32 s49, s41, 18
    v_add_u32 v3, s49, v2
    v_lshrrev_b32 v176, 4, v3
    v_lshl_add_u32 v176, v176, 10, v9
    v_bfe_u32 v5, v3, 2, 1
    v_lshl_add_u32 v176, v5, 9, v176
    v_bfe_u32 v5, v3, 3, 1
    v_lshl_add_u32 v176, v5, 3, v176
    v_and_b32 v5, 3, v3
    v_lshl_add_u32 v176, v5, 1, v176
    v_add_u32 v3, s49, v2
    v_add_u32 v3, 2, v3
    v_lshrrev_b32 v177, 4, v3
    v_lshl_add_u32 v177, v177, 10, v9
    v_bfe_u32 v5, v3, 2, 1
    v_lshl_add_u32 v177, v5, 9, v177
    v_bfe_u32 v5, v3, 3, 1
    v_lshl_add_u32 v177, v5, 3, v177
    v_and_b32 v5, 3, v3
    v_lshl_add_u32 v177, v5, 1, v177
    v_add_u32 v3, s49, v2
    v_add_u32 v3, 8, v3
    v_lshrrev_b32 v178, 4, v3
    v_lshl_add_u32 v178, v178, 10, v9
    v_bfe_u32 v5, v3, 2, 1
    v_lshl_add_u32 v178, v5, 9, v178
    v_bfe_u32 v5, v3, 3, 1
    v_lshl_add_u32 v178, v5, 3, v178
    v_and_b32 v5, 3, v3
    v_lshl_add_u32 v178, v5, 1, v178
    v_add_u32 v3, s49, v2
    v_add_u32 v3, 10, v3
    v_lshrrev_b32 v179, 4, v3
    v_lshl_add_u32 v179, v179, 10, v9
    v_bfe_u32 v5, v3, 2, 1
    v_lshl_add_u32 v179, v5, 9, v179
    v_bfe_u32 v5, v3, 3, 1
    v_lshl_add_u32 v179, v5, 3, v179
    v_and_b32 v5, 3, v3
    v_lshl_add_u32 v179, v5, 1, v179
    v_mov_b32 v3, s49
    v_add_u32 v3, 16, v3
    v_lshrrev_b32 v180, 4, v3
    v_lshl_add_u32 v180, v180, 10, v9
    v_bfe_u32 v5, v3, 2, 1
    v_lshl_add_u32 v180, v5, 9, v180
    v_bfe_u32 v5, v3, 3, 1
    v_lshl_add_u32 v180, v5, 3, v180
    v_and_b32 v5, 3, v3
    v_lshl_add_u32 v180, v5, 1, v180
    s_mul_i32 s49, s41, 18
    s_add_u32 s49, s49, 18
    v_add_u32 v3, s49, v2
    v_lshrrev_b32 v181, 4, v3
    v_lshl_add_u32 v181, v181, 10, v9
    v_bfe_u32 v5, v3, 2, 1
    v_lshl_add_u32 v181, v5, 9, v181
    v_bfe_u32 v5, v3, 3, 1
    v_lshl_add_u32 v181, v5, 3, v181
    v_and_b32 v5, 3, v3
    v_lshl_add_u32 v181, v5, 1, v181
    v_add_u32 v3, s49, v2
    v_add_u32 v3, 2, v3
    v_lshrrev_b32 v182, 4, v3
    v_lshl_add_u32 v182, v182, 10, v9
    v_bfe_u32 v5, v3, 2, 1
    v_lshl_add_u32 v182, v5, 9, v182
    v_bfe_u32 v5, v3, 3, 1
    v_lshl_add_u32 v182, v5, 3, v182
    v_and_b32 v5, 3, v3
    v_lshl_add_u32 v182, v5, 1, v182
    v_add_u32 v3, s49, v2
    v_add_u32 v3, 8, v3
    v_lshrrev_b32 v183, 4, v3
    v_lshl_add_u32 v183, v183, 10, v9
    v_bfe_u32 v5, v3, 2, 1
    v_lshl_add_u32 v183, v5, 9, v183
    v_bfe_u32 v5, v3, 3, 1
    v_lshl_add_u32 v183, v5, 3, v183
    v_and_b32 v5, 3, v3
    v_lshl_add_u32 v183, v5, 1, v183
    v_add_u32 v3, s49, v2
    v_add_u32 v3, 10, v3
    v_lshrrev_b32 v184, 4, v3
    v_lshl_add_u32 v184, v184, 10, v9
    v_bfe_u32 v5, v3, 2, 1
    v_lshl_add_u32 v184, v5, 9, v184
    v_bfe_u32 v5, v3, 3, 1
    v_lshl_add_u32 v184, v5, 3, v184
    v_and_b32 v5, 3, v3
    v_lshl_add_u32 v184, v5, 1, v184
    v_mov_b32 v3, s49
    v_add_u32 v3, 16, v3
    v_lshrrev_b32 v185, 4, v3
    v_lshl_add_u32 v185, v185, 10, v9
    v_bfe_u32 v5, v3, 2, 1
    v_lshl_add_u32 v185, v5, 9, v185
    v_bfe_u32 v5, v3, 3, 1
    v_lshl_add_u32 v185, v5, 3, v185
    v_and_b32 v5, 3, v3
    v_lshl_add_u32 v185, v5, 1, v185
    v_add_u32 v6, 98304, v11
    v_and_b32 v2, 31, v1
    v_lshlrev_b32 v7, 2, v2
    v_add_u32 v7, 99328, v7
    v_min_u32 v3, 18, v2
    v_lshrrev_b32 v4, 5, v1
    v_mul_u32_u24 v4, 19, v4
    v_add_u32 v3, v3, v4
    v_lshlrev_b32 v3, 4, v3
    v_add_u32 v8, 99456, v3
    v_mov_b32 v18, 159744
    v_mov_b32 v19, 1
    v_mov_b32 v17, 0
    v_mov_b32 v25, 0
    v_mov_b32 v33, 0
    v_mov_b32 v41, 0
    v_mov_b32 v144, 0
    v_mov_b32 v145, 0
    v_mov_b32 v146, 0
    v_mov_b32 v147, 0
    v_mov_b32 v148, 0
    v_mov_b32 v149, 0
    v_mov_b32 v150, 0
    v_mov_b32 v151, 0
    v_mov_b32 v152, 0
    v_mov_b32 v153, 0
    v_mov_b32 v154, 0
    v_mov_b32 v155, 0
    v_mov_b32 v156, 0
    v_mov_b32 v157, 0
    v_mov_b32 v158, 0
    v_mov_b32 v159, 0
    v_mov_b32 v160, 0
    v_mov_b32 v161, 0
    v_mov_b32 v162, 0
    v_mov_b32 v163, 0
    v_mov_b32 v164, 0
    v_mov_b32 v165, 0
    v_mov_b32 v166, 0
    v_mov_b32 v167, 0
    v_mov_b32 v168, 0
    v_mov_b32 v169, 0
    v_mov_b32 v170, 0
    v_mov_b32 v171, 0
    v_mov_b32 v172, 0
    v_mov_b32 v173, 0
    v_mov_b32 v174, 0
    v_mov_b32 v175, 0
    v_mov_b32 v68, 0
    v_mov_b32 v69, 0
    v_mov_b32 v70, 0
    v_mov_b32 v71, 0
    v_mov_b32 v72, 0
    v_mov_b32 v73, 0
    v_mov_b32 v74, 0
    v_mov_b32 v75, 0
    v_mov_b32 v44, 0
    v_mov_b32 v45, 0
    v_mov_b32 v46, 0
    v_mov_b32 v47, 0
    v_mov_b32 v48, 0
    v_mov_b32 v49, 0
    v_mov_b32 v50, 0
    v_mov_b32 v51, 0
    v_mov_b32 v52, 0
    v_mov_b32 v53, 0
    v_mov_b32 v54, 0
    v_mov_b32 v55, 0
    v_mov_b32 v56, 0
    v_mov_b32 v57, 0
    v_mov_b32 v58, 0
    v_mov_b32 v59, 0
    s_mov_b32 s56, 0x0007ffff
    s_mov_b32 s57, 0x0007ffff
    s_mov_b32 s53, 0
    s_mov_b32 s54, 4
    s_mov_b32 s51, 0
    s_lshl_b32 s61, s42, 4
    s_add_u32 s61, s61, s62
    s_lshl_b32 s61, s61, 7
    s_add_u32 s61, s61, 22609920
    v_mov_b32 v2, 0
    v_lshlrev_b32 v5, 2, v1
    v_and_b32 v5, 127, v5
    s_mov_b32 s58, 0
    s_cmp_lt_u32 s39, 2
    s_cbranch_scc1 at_sync
    s_branch at_wl
at_sync:
    s_cmp_eq_u32 s39, 1
    s_cbranch_scc1 at_prod
at_g0:
    s_sleep 6
    ds_read_b32 v26, v18 offset:4
    s_waitcnt lgkmcnt(0)
    v_readfirstlane_b32 s60, v26
    s_cmp_lt_u32 s60, 4
    s_cbranch_scc1 at_g0
    buffer_store_dword v2, v5, s[12:15], s61 offen sc1
    s_waitcnt vmcnt(0)
    s_mov_b64 exec, 1
    buffer_atomic_add v19, v2, s[20:23], 4 offen sc1
    ds_write_b32 v18, v19 offset:20
    s_mov_b64 exec, -1
    s_lshl_b32 s44, s42, 2
    s_add_u32 s44, s44, 64
at_g1:
    s_sleep 6
    ds_read_b32 v26, v18 offset:4
    s_waitcnt lgkmcnt(0)
    v_readfirstlane_b32 s60, v26
    s_cmp_lt_u32 s60, 16
    s_cbranch_scc1 at_g1
at_wg:
    s_sleep 4
    s_buffer_load_dwordx16 s[64:79], s[12:15], s61 glc
    s_add_u32 s58, s58, 1
    s_waitcnt lgkmcnt(0)
    s_and_b32 s55, s64, s65
    s_or_b32 s59, s64, s65
    s_and_b32 s55, s55, s66
    s_or_b32 s59, s59, s66
    s_and_b32 s55, s55, s67
    s_or_b32 s59, s59, s67
    s_and_b32 s55, s55, s68
    s_or_b32 s59, s59, s68
    s_and_b32 s55, s55, s69
    s_or_b32 s59, s59, s69
    s_and_b32 s55, s55, s70
    s_or_b32 s59, s59, s70
    s_and_b32 s55, s55, s71
    s_or_b32 s59, s59, s71
    s_and_b32 s55, s55, s72
    s_or_b32 s59, s59, s72
    s_and_b32 s55, s55, s73
    s_or_b32 s59, s59, s73
    s_and_b32 s55, s55, s74
    s_or_b32 s59, s59, s74
    s_and_b32 s55, s55, s75
    s_or_b32 s59, s59, s75
    s_and_b32 s55, s55, s76
    s_or_b32 s59, s59, s76
    s_and_b32 s55, s55, s77
    s_or_b32 s59, s59, s77
    s_and_b32 s55, s55, s78
    s_or_b32 s59, s59, s78
    s_and_b32 s55, s55, s79
    s_or_b32 s59, s59, s79
    s_cmp_ge_u32 s58, 32768
    s_cbranch_scc1 at_wg_done
    s_cmp_lg_u32 s55, 1
    s_cbranch_scc1 at_wg
    s_cmp_lg_u32 s59, 1
    s_cbranch_scc1 at_wg
at_wg_done:
    ds_write_b32 v18, v19 offset:8
    s_branch at_go
at_prod:
    s_and_b32 s63, s62, 1
    s_cmp_eq_u32 s62, 2
    s_cselect_b32 s63, 1, s63
    s_cmp_eq_u32 s62, 6
    s_cselect_b32 s63, 2, s63
    s_cmp_eq_u32 s63, 0
    s_cbranch_scc1 at_wl
    v_lshlrev_b32 v3, 7, v1
    s_lshl_b32 s59, s42, 2
    s_add_u32 s59, s59, 64
at_pw:
    s_sleep 1
    ds_read_b32 v26, v18 offset:16
    s_waitcnt lgkmcnt(0)
    v_readfirstlane_b32 s60, v26
    s_cmp_lt_u32 s60, 4
    s_cbranch_scc1 at_pw
    s_cmp_eq_u32 s63, 2
    s_cbranch_scc1 at_pr
    s_mov_b64 exec, 1
    buffer_atomic_add v19, v2, s[20:23], s59 offen sc1
    s_mov_b64 exec, -1
    s_branch at_wl
at_pr:
    s_sleep 2
    s_buffer_load_dword s60, s[20:23], 4 glc
    s_buffer_load_dword s55, s[20:23], s59 glc
    s_add_u32 s58, s58, 1
    s_waitcnt lgkmcnt(0)
    s_cmp_ge_u32 s58, 32768
    s_cbranch_scc1 at_pkv
    s_cmp_lt_u32 s60, 256
    s_cbranch_scc1 at_pr
    s_cmp_lt_u32 s55, 9
    s_cbranch_scc1 at_pr
at_pkv:
    s_lshl_b32 s59, s42, 2
    s_add_u32 s60, s59, 22609920
    buffer_store_dword v19, v3, s[12:15], s60 offen sc1
    s_add_u32 s60, s59, 22618112
    buffer_store_dword v19, v3, s[12:15], s60 offen sc1
    s_add_u32 s60, s59, 22626304
    buffer_store_dword v19, v3, s[12:15], s60 offen sc1
    s_add_u32 s60, s59, 22634496
    buffer_store_dword v19, v3, s[12:15], s60 offen sc1
at_wl:
    s_sleep 4
    ds_read_b32 v26, v18 offset:8
    s_waitcnt lgkmcnt(0)
    v_readfirstlane_b32 s55, v26
    s_cmp_eq_u32 s55, 0
    s_cbranch_scc1 at_wl
at_go:
    s_setprio 1
    s_mov_b32 m0, s47
    s_nop 0
    buffer_load_dwordx4 v11, s[12:15], s46 offen offset:0 sc1 lds
    buffer_load_dwordx4 v11, s[12:15], s46 offen offset:1024 sc1 lds
    buffer_load_dwordx4 v11, s[12:15], s46 offen offset:2048 sc1 lds
    buffer_load_dwordx4 v11, s[12:15], s46 offen offset:3072 sc1 lds
    s_add_u32 m0, s47, 4096
    s_add_u32 s45, s46, 4096
    buffer_load_dwordx4 v11, s[12:15], s45 offen sc1 lds
    s_add_u32 s46, s46, 18944
    s_add_u32 s47, s47, 20480
    buffer_load_dword v12, v176, s[12:15], s48 offen sc1
    buffer_load_dword v13, v177, s[12:15], s48 offen sc1
    buffer_load_dword v14, v178, s[12:15], s48 offen sc1
    buffer_load_dword v15, v179, s[12:15], s48 offen sc1
    buffer_load_dword v16, v180, s[12:15], s48 offen sc1
    buffer_load_dword v20, v181, s[12:15], s48 offen sc1
    buffer_load_dword v21, v182, s[12:15], s48 offen sc1
    buffer_load_dword v22, v183, s[12:15], s48 offen sc1
    buffer_load_dword v23, v184, s[12:15], s48 offen sc1
    buffer_load_dword v24, v185, s[12:15], s48 offen sc1
    s_mov_b32 m0, s47
    s_nop 0
    buffer_load_dwordx4 v11, s[12:15], s46 offen offset:0 sc1 lds
    buffer_load_dwordx4 v11, s[12:15], s46 offen offset:1024 sc1 lds
    buffer_load_dwordx4 v11, s[12:15], s46 offen offset:2048 sc1 lds
    buffer_load_dwordx4 v11, s[12:15], s46 offen offset:3072 sc1 lds
    s_add_u32 m0, s47, 4096
    s_add_u32 s45, s46, 4096
    buffer_load_dwordx4 v11, s[12:15], s45 offen sc1 lds
    s_add_u32 s46, s46, 18944
    s_add_u32 s47, s47, 20480
    s_waitcnt vmcnt(5)
    s_mov_b64 exec, 1
    ds_add_u32 v18, v19
    s_mov_b64 exec, -1
at_poll0:
    ds_read_b32 v26, v18
    s_waitcnt lgkmcnt(0)
    v_readfirstlane_b32 s55, v26
    s_cmp_lt_u32 s55, s54
    s_cbranch_scc1 at_poll0
    ds_read_b128 v[28:31], v6 offset:0
    ds_read_b32 v32, v7 offset:0
    v_cmp_gt_u32 vcc, 32, v1
    s_nop 1
    v_cndmask_b32 v16, 0, v16, vcc
    v_cndmask_b32 v24, 0, v24, vcc
    s_waitcnt lgkmcnt(0)
    v_mfma_f32_32x32x16_bf16 v[80:95], v[28:31], v[12:15], 0
    v_mfma_f32_32x32x8_bf16 v[80:95], v[32:33], v[16:17], v[80:95]
    v_mfma_f32_32x32x16_bf16 v[96:111], v[28:31], v[20:23], 0
    v_mfma_f32_32x32x8_bf16 v[96:111], v[32:33], v[24:25], v[96:111]
    s_nop 7
    s_nop 1
    v_max3_f32 v2, v80, v81, v82
    v_max3_f32 v2, v2, v83, v84
    v_max3_f32 v2, v2, v85, v86
    v_max3_f32 v2, v2, v87, v88
    v_max3_f32 v2, v2, v89, v90
    v_max3_f32 v2, v2, v91, v92
    v_max3_f32 v2, v2, v93, v94
    v_max_f32 v2, v2, v95
    v_max3_f32 v4, v96, v97, v98
    v_max3_f32 v4, v4, v99, v100
    v_max3_f32 v4, v4, v101, v102
    v_max3_f32 v4, v4, v103, v104
    v_max3_f32 v4, v4, v105, v106
    v_max3_f32 v4, v4, v107, v108
    v_max3_f32 v4, v4, v109, v110
    v_max_f32 v4, v4, v111
    v_mov_b32 v3, v2
    s_nop 1
    v_permlane32_swap_b32 v2, v3
    s_nop 1
    v_max_f32 v2, v2, v3
    v_mov_b32 v5, v4
    s_nop 1
    v_permlane32_swap_b32 v4, v5
    s_nop 1
    v_max_f32 v4, v4, v5
    v_add_f32 v2, 1119879168, v2
    v_sub_f32 v2, 0, v2
    v_mov_b32 v112, v2
    v_mov_b32 v113, v2
    v_mov_b32 v114, v2
    v_mov_b32 v115, v2
    v_mov_b32 v116, v2
    v_mov_b32 v117, v2
    v_mov_b32 v118, v2
    v_mov_b32 v119, v2
    v_mov_b32 v120, v2
    v_mov_b32 v121, v2
    v_mov_b32 v122, v2
    v_mov_b32 v123, v2
    v_mov_b32 v124, v2
    v_mov_b32 v125, v2
    v_mov_b32 v126, v2
    v_mov_b32 v127, v2
    v_add_f32 v4, 1119879168, v4
    v_sub_f32 v4, 0, v4
    v_mov_b32 v128, v4
    v_mov_b32 v129, v4
    v_mov_b32 v130, v4
    v_mov_b32 v131, v4
    v_mov_b32 v132, v4
    v_mov_b32 v133, v4
    v_mov_b32 v134, v4
    v_mov_b32 v135, v4
    v_mov_b32 v136, v4
    v_mov_b32 v137, v4
    v_mov_b32 v138, v4
    v_mov_b32 v139, v4
    v_mov_b32 v140, v4
    v_mov_b32 v141, v4
    v_mov_b32 v142, v4
    v_mov_b32 v143, v4
    v_add_f32 v80, v80, v2
    v_add_f32 v81, v81, v2
    v_add_f32 v82, v82, v2
    v_add_f32 v83, v83, v2
    v_add_f32 v84, v84, v2
    v_add_f32 v85, v85, v2
    v_add_f32 v86, v86, v2
    v_add_f32 v87, v87, v2
    v_add_f32 v88, v88, v2
    v_add_f32 v89, v89, v2
    v_add_f32 v90, v90, v2
    v_add_f32 v91, v91, v2
    v_add_f32 v92, v92, v2
    v_add_f32 v93, v93, v2
    v_add_f32 v94, v94, v2
    v_add_f32 v95, v95, v2
at_loop:
    s_nop 2
    v_cmp_nlt_f32 vcc, v154, v10
    s_cmp_lg_u32 vcc_lo, 0
    s_cbranch_scc1 at_rca
at_rca_ret:
    v_mfma_f32_32x32x16_bf16 v[96:111], v[28:31], v[20:23], v[128:143]
    v_exp_f32 v80, v80
    v_exp_f32 v81, v81
    v_exp_f32 v82, v82
    v_mfma_f32_32x32x16_bf16 v[160:175], v[52:55], v[68:71], v[160:175]
    ds_read_b128 v[36:39], v6 offset:2368
    ds_read_b32 v40, v7 offset:2368
    v_exp_f32 v83, v83
    v_cvt_pk_bf16_f32 v60, v80, v81
    v_exp_f32 v84, v84
    v_cvt_pk_bf16_f32 v61, v82, v83
    v_exp_f32 v85, v85
    v_exp_f32 v86, v86
    v_exp_f32 v87, v87
    v_cvt_pk_bf16_f32 v62, v84, v85
    v_cvt_pk_bf16_f32 v63, v86, v87
    v_mfma_f32_32x32x8_bf16 v[96:111], v[32:33], v[24:25], v[96:111]
    s_mov_b64 exec, s[56:57]
    ds_read_b128 v[44:47], v8 offset:0
    ds_read_b128 v[48:51], v8 offset:608
    s_mov_b64 exec, -1
    v_exp_f32 v88, v88
    v_exp_f32 v89, v89
    v_exp_f32 v90, v90
    v_mfma_f32_32x32x16_bf16 v[160:175], v[56:59], v[72:75], v[160:175]
    v_exp_f32 v91, v91
    v_cvt_pk_bf16_f32 v64, v88, v89
    v_exp_f32 v92, v92
    v_cvt_pk_bf16_f32 v65, v90, v91
    v_exp_f32 v93, v93
    v_exp_f32 v94, v94
    v_exp_f32 v95, v95
    v_cvt_pk_bf16_f32 v66, v92, v93
    v_cvt_pk_bf16_f32 v67, v94, v95
    s_nop 2
    v_cmp_nlt_f32 vcc, v170, v10
    s_cmp_lg_u32 vcc_lo, 0
    s_cbranch_scc1 at_rcb
at_rcb_ret:
    s_waitcnt lgkmcnt(0)
    v_mfma_f32_32x32x16_bf16 v[80:95], v[36:39], v[12:15], v[112:127]
    v_exp_f32 v96, v96
    v_exp_f32 v97, v97
    v_exp_f32 v98, v98
    v_mfma_f32_32x32x16_bf16 v[144:159], v[44:47], v[60:63], v[144:159]
    v_exp_f32 v99, v99
    v_cvt_pk_bf16_f32 v68, v96, v97
    v_exp_f32 v100, v100
    v_cvt_pk_bf16_f32 v69, v98, v99
    v_exp_f32 v101, v101
    v_exp_f32 v102, v102
    v_exp_f32 v103, v103
    v_cvt_pk_bf16_f32 v70, v100, v101
    v_cvt_pk_bf16_f32 v71, v102, v103
    v_mfma_f32_32x32x8_bf16 v[80:95], v[40:41], v[16:17], v[80:95]
    v_exp_f32 v104, v104
    v_exp_f32 v105, v105
    v_exp_f32 v106, v106
    v_mfma_f32_32x32x16_bf16 v[144:159], v[48:51], v[64:67], v[144:159]
    v_exp_f32 v107, v107
    v_cvt_pk_bf16_f32 v72, v104, v105
    v_exp_f32 v108, v108
    v_cvt_pk_bf16_f32 v73, v106, v107
    v_exp_f32 v109, v109
    v_exp_f32 v110, v110
    v_exp_f32 v111, v111
    v_cvt_pk_bf16_f32 v74, v108, v109
    v_cvt_pk_bf16_f32 v75, v110, v111
    v_mfma_f32_32x32x16_bf16 v[96:111], v[36:39], v[20:23], v[128:143]
    v_exp_f32 v80, v80
    v_exp_f32 v81, v81
    v_exp_f32 v82, v82
    v_mfma_f32_32x32x16_bf16 v[160:175], v[44:47], v[68:71], v[160:175]
    ds_read_b128 v[28:31], v6 offset:4736
    ds_read_b32 v32, v7 offset:4736
    v_exp_f32 v83, v83
    v_cvt_pk_bf16_f32 v60, v80, v81
    v_exp_f32 v84, v84
    v_cvt_pk_bf16_f32 v61, v82, v83
    v_exp_f32 v85, v85
    v_exp_f32 v86, v86
    v_exp_f32 v87, v87
    v_cvt_pk_bf16_f32 v62, v84, v85
    v_cvt_pk_bf16_f32 v63, v86, v87
    v_mfma_f32_32x32x8_bf16 v[96:111], v[40:41], v[24:25], v[96:111]
    s_mov_b64 exec, s[56:57]
    ds_read_b128 v[52:55], v8 offset:2368
    ds_read_b128 v[56:59], v8 offset:2976
    s_mov_b64 exec, -1
    v_exp_f32 v88, v88
    v_exp_f32 v89, v89
    v_exp_f32 v90, v90
    v_mfma_f32_32x32x16_bf16 v[160:175], v[48:51], v[72:75], v[160:175]
    v_exp_f32 v91, v91
    v_cvt_pk_bf16_f32 v64, v88, v89
    v_exp_f32 v92, v92
    v_cvt_pk_bf16_f32 v65, v90, v91
    v_exp_f32 v93, v93
    v_exp_f32 v94, v94
    v_exp_f32 v95, v95
    v_cvt_pk_bf16_f32 v66, v92, v93
    v_cvt_pk_bf16_f32 v67, v94, v95
    s_waitcnt lgkmcnt(0)
    v_mfma_f32_32x32x16_bf16 v[80:95], v[28:31], v[12:15], v[112:127]
    v_exp_f32 v96, v96
    v_exp_f32 v97, v97
    v_exp_f32 v98, v98
    v_mfma_f32_32x32x16_bf16 v[144:159], v[52:55], v[60:63], v[144:159]
    s_waitcnt vmcnt(0)
    s_mov_b64 exec, 1
    ds_add_u32 v18, v19
    s_mov_b64 exec, -1
    s_add_u32 s54, s54, 4
    v_exp_f32 v99, v99
    v_cvt_pk_bf16_f32 v68, v96, v97
    v_exp_f32 v100, v100
    v_cvt_pk_bf16_f32 v69, v98, v99
    v_exp_f32 v101, v101
    v_exp_f32 v102, v102
    v_exp_f32 v103, v103
    v_cvt_pk_bf16_f32 v70, v100, v101
    v_cvt_pk_bf16_f32 v71, v102, v103
    v_mfma_f32_32x32x8_bf16 v[80:95], v[32:33], v[16:17], v[80:95]
    v_exp_f32 v104, v104
    v_exp_f32 v105, v105
    v_exp_f32 v106, v106
    v_mfma_f32_32x32x16_bf16 v[144:159], v[56:59], v[64:67], v[144:159]
    s_add_u32 s53, s53, 1
    s_cmp_eq_u32 s53, 3
    s_cselect_b32 s53, 0, s53
    s_mov_b32 s52, 20480
    s_cselect_b32 s52, 4294926336, s52
    v_exp_f32 v107, v107
    v_cvt_pk_bf16_f32 v72, v104, v105
    v_exp_f32 v108, v108
    v_cvt_pk_bf16_f32 v73, v106, v107
    v_exp_f32 v109, v109
    v_exp_f32 v110, v110
    v_exp_f32 v111, v111
    v_cvt_pk_bf16_f32 v74, v108, v109
    v_cvt_pk_bf16_f32 v75, v110, v111
    v_mfma_f32_32x32x16_bf16 v[96:111], v[28:31], v[20:23], v[128:143]
    v_exp_f32 v80, v80
    v_exp_f32 v81, v81
    v_exp_f32 v82, v82
    v_mfma_f32_32x32x16_bf16 v[160:175], v[52:55], v[68:71], v[160:175]
    ds_read_b128 v[36:39], v6 offset:7104
    ds_read_b32 v40, v7 offset:7104
    v_exp_f32 v83, v83
    v_cvt_pk_bf16_f32 v60, v80, v81
    v_exp_f32 v84, v84
    v_cvt_pk_bf16_f32 v61, v82, v83
    v_exp_f32 v85, v85
    v_exp_f32 v86, v86
    v_exp_f32 v87, v87
    v_cvt_pk_bf16_f32 v62, v84, v85
    v_cvt_pk_bf16_f32 v63, v86, v87
    v_mfma_f32_32x32x8_bf16 v[96:111], v[32:33], v[24:25], v[96:111]
    s_mov_b64 exec, s[56:57]
    ds_read_b128 v[44:47], v8 offset:4736
    ds_read_b128 v[48:51], v8 offset:5344
    s_mov_b64 exec, -1
    v_exp_f32 v88, v88
    v_exp_f32 v89, v89
    v_exp_f32 v90, v90
    v_mfma_f32_32x32x16_bf16 v[160:175], v[56:59], v[72:75], v[160:175]
    v_exp_f32 v91, v91
    v_cvt_pk_bf16_f32 v64, v88, v89
    v_exp_f32 v92, v92
    v_cvt_pk_bf16_f32 v65, v90, v91
    v_exp_f32 v93, v93
    v_exp_f32 v94, v94
    v_exp_f32 v95, v95
    v_cvt_pk_bf16_f32 v66, v92, v93
    v_cvt_pk_bf16_f32 v67, v94, v95
    s_waitcnt lgkmcnt(0)
    v_mfma_f32_32x32x16_bf16 v[80:95], v[36:39], v[12:15], v[112:127]
    v_exp_f32 v96, v96
    v_exp_f32 v97, v97
    v_exp_f32 v98, v98
    v_mfma_f32_32x32x16_bf16 v[144:159], v[44:47], v[60:63], v[144:159]
    v_exp_f32 v99, v99
    v_cvt_pk_bf16_f32 v68, v96, v97
    v_exp_f32 v100, v100
    v_cvt_pk_bf16_f32 v69, v98, v99
    v_exp_f32 v101, v101
    v_exp_f32 v102, v102
    v_exp_f32 v103, v103
    v_cvt_pk_bf16_f32 v70, v100, v101
    v_cvt_pk_bf16_f32 v71, v102, v103
    v_mfma_f32_32x32x8_bf16 v[80:95], v[40:41], v[16:17], v[80:95]
    v_exp_f32 v104, v104
    v_exp_f32 v105, v105
    v_exp_f32 v106, v106
    v_mfma_f32_32x32x16_bf16 v[144:159], v[48:51], v[64:67], v[144:159]
    v_exp_f32 v107, v107
    v_cvt_pk_bf16_f32 v72, v104, v105
    v_exp_f32 v108, v108
    v_cvt_pk_bf16_f32 v73, v106, v107
    v_exp_f32 v109, v109
    v_exp_f32 v110, v110
    v_exp_f32 v111, v111
    v_cvt_pk_bf16_f32 v74, v108, v109
    v_cvt_pk_bf16_f32 v75, v110, v111
    v_mfma_f32_32x32x16_bf16 v[96:111], v[36:39], v[20:23], v[128:143]
    v_exp_f32 v80, v80
    v_exp_f32 v81, v81
    v_exp_f32 v82, v82
    v_mfma_f32_32x32x16_bf16 v[160:175], v[44:47], v[68:71], v[160:175]
    ds_read_b128 v[28:31], v6 offset:9472
    ds_read_b32 v32, v7 offset:9472
    v_exp_f32 v83, v83
    v_cvt_pk_bf16_f32 v60, v80, v81
    v_exp_f32 v84, v84
    v_cvt_pk_bf16_f32 v61, v82, v83
    v_exp_f32 v85, v85
    v_exp_f32 v86, v86
    v_exp_f32 v87, v87
    v_cvt_pk_bf16_f32 v62, v84, v85
    v_cvt_pk_bf16_f32 v63, v86, v87
    v_mfma_f32_32x32x8_bf16 v[96:111], v[40:41], v[24:25], v[96:111]
    s_mov_b64 exec, s[56:57]
    ds_read_b128 v[52:55], v8 offset:7104
    ds_read_b128 v[56:59], v8 offset:7712
    s_mov_b64 exec, -1
    v_exp_f32 v88, v88
    v_exp_f32 v89, v89
    v_exp_f32 v90, v90
    v_mfma_f32_32x32x16_bf16 v[160:175], v[48:51], v[72:75], v[160:175]
    v_exp_f32 v91, v91
    v_cvt_pk_bf16_f32 v64, v88, v89
    v_exp_f32 v92, v92
    v_cvt_pk_bf16_f32 v65, v90, v91
    v_exp_f32 v93, v93
    v_exp_f32 v94, v94
    v_exp_f32 v95, v95
    v_cvt_pk_bf16_f32 v66, v92, v93
    v_cvt_pk_bf16_f32 v67, v94, v95
    s_waitcnt lgkmcnt(0)
    v_mfma_f32_32x32x16_bf16 v[80:95], v[28:31], v[12:15], v[112:127]
    v_exp_f32 v96, v96
    v_exp_f32 v97, v97
    v_exp_f32 v98, v98
    v_mfma_f32_32x32x16_bf16 v[144:159], v[52:55], v[60:63], v[144:159]
    v_exp_f32 v99, v99
    v_cvt_pk_bf16_f32 v68, v96, v97
    v_exp_f32 v100, v100
    v_cvt_pk_bf16_f32 v69, v98, v99
    v_exp_f32 v101, v101
    v_exp_f32 v102, v102
    v_exp_f32 v103, v103
    v_cvt_pk_bf16_f32 v70, v100, v101
    v_cvt_pk_bf16_f32 v71, v102, v103
    v_mfma_f32_32x32x8_bf16 v[80:95], v[32:33], v[16:17], v[80:95]
    v_exp_f32 v104, v104
    v_exp_f32 v105, v105
    v_exp_f32 v106, v106
    v_mfma_f32_32x32x16_bf16 v[144:159], v[56:59], v[64:67], v[144:159]
    v_exp_f32 v107, v107
    v_cvt_pk_bf16_f32 v72, v104, v105
    v_exp_f32 v108, v108
    v_cvt_pk_bf16_f32 v73, v106, v107
    v_exp_f32 v109, v109
    v_exp_f32 v110, v110
    v_exp_f32 v111, v111
    v_cvt_pk_bf16_f32 v74, v108, v109
    v_cvt_pk_bf16_f32 v75, v110, v111
    v_mfma_f32_32x32x16_bf16 v[96:111], v[28:31], v[20:23], v[128:143]
    v_exp_f32 v80, v80
    v_exp_f32 v81, v81
    v_exp_f32 v82, v82
    v_mfma_f32_32x32x16_bf16 v[160:175], v[52:55], v[68:71], v[160:175]
    ds_read_b128 v[36:39], v6 offset:11840
    ds_read_b32 v40, v7 offset:11840
    v_exp_f32 v83, v83
    v_cvt_pk_bf16_f32 v60, v80, v81
    v_exp_f32 v84, v84
    v_cvt_pk_bf16_f32 v61, v82, v83
    v_exp_f32 v85, v85
    v_exp_f32 v86, v86
    v_exp_f32 v87, v87
    v_cvt_pk_bf16_f32 v62, v84, v85
    v_cvt_pk_bf16_f32 v63, v86, v87
    v_mfma_f32_32x32x8_bf16 v[96:111], v[32:33], v[24:25], v[96:111]
    s_mov_b64 exec, s[56:57]
    ds_read_b128 v[44:47], v8 offset:9472
    ds_read_b128 v[48:51], v8 offset:10080
    s_mov_b64 exec, -1
    v_exp_f32 v88, v88
    v_exp_f32 v89, v89
    v_exp_f32 v90, v90
    v_mfma_f32_32x32x16_bf16 v[160:175], v[56:59], v[72:75], v[160:175]
    ds_read_b32 v26, v18
    v_exp_f32 v91, v91
    v_cvt_pk_bf16_f32 v64, v88, v89
    v_exp_f32 v92, v92
    v_cvt_pk_bf16_f32 v65, v90, v91
    v_exp_f32 v93, v93
    v_exp_f32 v94, v94
    v_exp_f32 v95, v95
    v_cvt_pk_bf16_f32 v66, v92, v93
    v_cvt_pk_bf16_f32 v67, v94, v95
    s_waitcnt lgkmcnt(0)
    v_mfma_f32_32x32x16_bf16 v[80:95], v[36:39], v[12:15], v[112:127]
    v_exp_f32 v96, v96
    v_exp_f32 v97, v97
    v_exp_f32 v98, v98
    v_mfma_f32_32x32x16_bf16 v[144:159], v[44:47], v[60:63], v[144:159]
    v_readfirstlane_b32 s55, v26
    s_cmp_lt_u32 s55, s54
    s_cbranch_scc1 at_poll
at_poll_ret:
    v_exp_f32 v99, v99
    v_cvt_pk_bf16_f32 v68, v96, v97
    v_exp_f32 v100, v100
    v_cvt_pk_bf16_f32 v69, v98, v99
    v_exp_f32 v101, v101
    v_exp_f32 v102, v102
    v_exp_f32 v103, v103
    v_cvt_pk_bf16_f32 v70, v100, v101
    v_cvt_pk_bf16_f32 v71, v102, v103
    v_mfma_f32_32x32x8_bf16 v[80:95], v[40:41], v[16:17], v[80:95]
    v_exp_f32 v104, v104
    v_exp_f32 v105, v105
    v_exp_f32 v106, v106
    v_mfma_f32_32x32x16_bf16 v[144:159], v[48:51], v[64:67], v[144:159]
    v_exp_f32 v107, v107
    v_cvt_pk_bf16_f32 v72, v104, v105
    v_exp_f32 v108, v108
    v_cvt_pk_bf16_f32 v73, v106, v107
    v_exp_f32 v109, v109
    v_exp_f32 v110, v110
    v_exp_f32 v111, v111
    v_cvt_pk_bf16_f32 v74, v108, v109
    v_cvt_pk_bf16_f32 v75, v110, v111
    v_mfma_f32_32x32x16_bf16 v[96:111], v[36:39], v[20:23], v[128:143]
    v_exp_f32 v80, v80
    v_exp_f32 v81, v81
    v_exp_f32 v82, v82
    v_mfma_f32_32x32x16_bf16 v[160:175], v[44:47], v[68:71], v[160:175]
    ds_read_b128 v[28:31], v6 offset:14208
    ds_read_b32 v32, v7 offset:14208
    s_mov_b32 m0, s47
    s_nop 0
    buffer_load_dwordx4 v11, s[12:15], s46 offen offset:0 sc1 lds
    v_exp_f32 v83, v83
    v_cvt_pk_bf16_f32 v60, v80, v81
    v_exp_f32 v84, v84
    v_cvt_pk_bf16_f32 v61, v82, v83
    v_exp_f32 v85, v85
    v_exp_f32 v86, v86
    v_exp_f32 v87, v87
    v_cvt_pk_bf16_f32 v62, v84, v85
    v_cvt_pk_bf16_f32 v63, v86, v87
    v_mfma_f32_32x32x8_bf16 v[96:111], v[40:41], v[24:25], v[96:111]
    s_mov_b64 exec, s[56:57]
    ds_read_b128 v[52:55], v8 offset:11840
    ds_read_b128 v[56:59], v8 offset:12448
    s_mov_b64 exec, -1
    v_exp_f32 v88, v88
    v_exp_f32 v89, v89
    v_exp_f32 v90, v90
    v_mfma_f32_32x32x16_bf16 v[160:175], v[48:51], v[72:75], v[160:175]
    buffer_load_dwordx4 v11, s[12:15], s46 offen offset:1024 sc1 lds
    buffer_load_dwordx4 v11, s[12:15], s46 offen offset:2048 sc1 lds
    v_exp_f32 v91, v91
    v_cvt_pk_bf16_f32 v64, v88, v89
    v_exp_f32 v92, v92
    v_cvt_pk_bf16_f32 v65, v90, v91
    v_exp_f32 v93, v93
    v_exp_f32 v94, v94
    v_exp_f32 v95, v95
    v_cvt_pk_bf16_f32 v66, v92, v93
    v_cvt_pk_bf16_f32 v67, v94, v95
    s_waitcnt lgkmcnt(0)
    v_mfma_f32_32x32x16_bf16 v[80:95], v[28:31], v[12:15], v[112:127]
    v_exp_f32 v96, v96
    v_exp_f32 v97, v97
    v_exp_f32 v98, v98
    v_mfma_f32_32x32x16_bf16 v[144:159], v[52:55], v[60:63], v[144:159]
    buffer_load_dwordx4 v11, s[12:15], s46 offen offset:3072 sc1 lds
    v_exp_f32 v99, v99
    v_cvt_pk_bf16_f32 v68, v96, v97
    v_exp_f32 v100, v100
    v_cvt_pk_bf16_f32 v69, v98, v99
    v_exp_f32 v101, v101
    v_exp_f32 v102, v102
    v_exp_f32 v103, v103
    v_cvt_pk_bf16_f32 v70, v100, v101
    v_cvt_pk_bf16_f32 v71, v102, v103
    v_mfma_f32_32x32x8_bf16 v[80:95], v[32:33], v[16:17], v[80:95]
    v_exp_f32 v104, v104
    v_exp_f32 v105, v105
    v_exp_f32 v106, v106
    v_mfma_f32_32x32x16_bf16 v[144:159], v[56:59], v[64:67], v[144:159]
    s_add_u32 m0, s47, 4096
    s_add_u32 s45, s46, 4096
    buffer_load_dwordx4 v11, s[12:15], s45 offen sc1 lds
    s_add_u32 s46, s46, 18944
    s_add_u32 s47, s47, 20480
    s_cmp_ge_u32 s47, 159744
    s_cselect_b32 s45, 61440, 0
    s_sub_u32 s47, s47, s45
    v_exp_f32 v107, v107
    v_cvt_pk_bf16_f32 v72, v104, v105
    v_exp_f32 v108, v108
    v_cvt_pk_bf16_f32 v73, v106, v107
    v_exp_f32 v109, v109
    v_exp_f32 v110, v110
    v_exp_f32 v111, v111
    v_cvt_pk_bf16_f32 v74, v108, v109
    v_cvt_pk_bf16_f32 v75, v110, v111
    v_mfma_f32_32x32x16_bf16 v[96:111], v[28:31], v[20:23], v[128:143]
    v_exp_f32 v80, v80
    v_exp_f32 v81, v81
    v_exp_f32 v82, v82
    v_mfma_f32_32x32x16_bf16 v[160:175], v[52:55], v[68:71], v[160:175]
    ds_read_b128 v[36:39], v6 offset:16576
    ds_read_b32 v40, v7 offset:16576
    v_exp_f32 v83, v83
    v_cvt_pk_bf16_f32 v60, v80, v81
    v_exp_f32 v84, v84
    v_cvt_pk_bf16_f32 v61, v82, v83
    v_exp_f32 v85, v85
    v_exp_f32 v86, v86
    v_exp_f32 v87, v87
    v_cvt_pk_bf16_f32 v62, v84, v85
    v_cvt_pk_bf16_f32 v63, v86, v87
    v_mfma_f32_32x32x8_bf16 v[96:111], v[32:33], v[24:25], v[96:111]
    s_mov_b64 exec, s[56:57]
    ds_read_b128 v[44:47], v8 offset:14208
    ds_read_b128 v[48:51], v8 offset:14816
    s_mov_b64 exec, -1
    v_exp_f32 v88, v88
    v_exp_f32 v89, v89
    v_exp_f32 v90, v90
    v_mfma_f32_32x32x16_bf16 v[160:175], v[56:59], v[72:75], v[160:175]
    v_exp_f32 v91, v91
    v_cvt_pk_bf16_f32 v64, v88, v89
    v_exp_f32 v92, v92
    v_cvt_pk_bf16_f32 v65, v90, v91
    v_exp_f32 v93, v93
    v_exp_f32 v94, v94
    v_exp_f32 v95, v95
    v_cvt_pk_bf16_f32 v66, v92, v93
    v_cvt_pk_bf16_f32 v67, v94, v95
    s_waitcnt lgkmcnt(0)
    v_mfma_f32_32x32x16_bf16 v[80:95], v[36:39], v[12:15], v[112:127]
    v_exp_f32 v96, v96
    v_exp_f32 v97, v97
    v_exp_f32 v98, v98
    v_mfma_f32_32x32x16_bf16 v[144:159], v[44:47], v[60:63], v[144:159]
    v_exp_f32 v99, v99
    v_cvt_pk_bf16_f32 v68, v96, v97
    v_exp_f32 v100, v100
    v_cvt_pk_bf16_f32 v69, v98, v99
    v_exp_f32 v101, v101
    v_exp_f32 v102, v102
    v_exp_f32 v103, v103
    v_cvt_pk_bf16_f32 v70, v100, v101
    v_cvt_pk_bf16_f32 v71, v102, v103
    v_mfma_f32_32x32x8_bf16 v[80:95], v[40:41], v[16:17], v[80:95]
    v_exp_f32 v104, v104
    v_exp_f32 v105, v105
    v_exp_f32 v106, v106
    v_mfma_f32_32x32x16_bf16 v[144:159], v[48:51], v[64:67], v[144:159]
    v_exp_f32 v107, v107
    v_cvt_pk_bf16_f32 v72, v104, v105
    v_exp_f32 v108, v108
    v_cvt_pk_bf16_f32 v73, v106, v107
    v_exp_f32 v109, v109
    v_exp_f32 v110, v110
    v_exp_f32 v111, v111
    v_cvt_pk_bf16_f32 v74, v108, v109
    v_cvt_pk_bf16_f32 v75, v110, v111
    v_mfma_f32_32x32x16_bf16 v[96:111], v[36:39], v[20:23], v[128:143]
    v_add_u32 v6, s52, v6
    v_add_u32 v7, s52, v7
    v_exp_f32 v80, v80
    v_exp_f32 v81, v81
    v_exp_f32 v82, v82
    v_mfma_f32_32x32x16_bf16 v[160:175], v[44:47], v[68:71], v[160:175]
    ds_read_b128 v[28:31], v6 offset:0
    ds_read_b32 v32, v7 offset:0
    v_exp_f32 v83, v83
    v_cvt_pk_bf16_f32 v60, v80, v81
    v_exp_f32 v84, v84
    v_cvt_pk_bf16_f32 v61, v82, v83
    v_exp_f32 v85, v85
    v_exp_f32 v86, v86
    v_exp_f32 v87, v87
    v_cvt_pk_bf16_f32 v62, v84, v85
    v_cvt_pk_bf16_f32 v63, v86, v87
    v_mfma_f32_32x32x8_bf16 v[96:111], v[40:41], v[24:25], v[96:111]
    s_mov_b64 exec, s[56:57]
    ds_read_b128 v[52:55], v8 offset:16576
    ds_read_b128 v[56:59], v8 offset:17184
    s_mov_b64 exec, -1
    v_exp_f32 v88, v88
    v_exp_f32 v89, v89
    v_exp_f32 v90, v90
    v_mfma_f32_32x32x16_bf16 v[160:175], v[48:51], v[72:75], v[160:175]
    v_exp_f32 v91, v91
    v_cvt_pk_bf16_f32 v64, v88, v89
    v_exp_f32 v92, v92
    v_cvt_pk_bf16_f32 v65, v90, v91
    v_exp_f32 v93, v93
    v_exp_f32 v94, v94
    v_exp_f32 v95, v95
    v_cvt_pk_bf16_f32 v66, v92, v93
    v_cvt_pk_bf16_f32 v67, v94, v95
    s_waitcnt lgkmcnt(0)
    v_mfma_f32_32x32x16_bf16 v[80:95], v[28:31], v[12:15], v[112:127]
    v_add_u32 v8, s52, v8
    v_exp_f32 v96, v96
    v_exp_f32 v97, v97
    v_exp_f32 v98, v98
    v_mfma_f32_32x32x16_bf16 v[144:159], v[52:55], v[60:63], v[144:159]
    v_exp_f32 v99, v99
    v_cvt_pk_bf16_f32 v68, v96, v97
    v_exp_f32 v100, v100
    v_cvt_pk_bf16_f32 v69, v98, v99
    v_exp_f32 v101, v101
    v_exp_f32 v102, v102
    v_exp_f32 v103, v103
    v_cvt_pk_bf16_f32 v70, v100, v101
    v_cvt_pk_bf16_f32 v71, v102, v103
    v_mfma_f32_32x32x8_bf16 v[80:95], v[32:33], v[16:17], v[80:95]
    v_exp_f32 v104, v104
    v_exp_f32 v105, v105
    v_exp_f32 v106, v106
    v_mfma_f32_32x32x16_bf16 v[144:159], v[56:59], v[64:67], v[144:159]
    v_exp_f32 v107, v107
    v_cvt_pk_bf16_f32 v72, v104, v105
    v_exp_f32 v108, v108
    v_cvt_pk_bf16_f32 v73, v106, v107
    v_exp_f32 v109, v109
    v_exp_f32 v110, v110
    v_exp_f32 v111, v111
    v_cvt_pk_bf16_f32 v74, v108, v109
    v_cvt_pk_bf16_f32 v75, v110, v111
    s_add_u32 s51, s51, 1
    s_cmp_lt_u32 s51, 8
    s_cbranch_scc1 at_loop
    v_mfma_f32_32x32x16_bf16 v[160:175], v[52:55], v[68:71], v[160:175]
    v_mfma_f32_32x32x16_bf16 v[160:175], v[56:59], v[72:75], v[160:175]
    s_mov_b32 s50, 0
at_finish:
    s_nop 7
    s_nop 3
    v_frexp_exp_i32_f32 v2, v154
    v_add_u32 v2, 96, v2
    v_mov_b32 v3, v2
    s_nop 1
    v_permlane32_swap_b32 v2, v3
    s_nop 1
    v_sub_u32 v3, 0, v2
    v_cvt_f32_i32 v4, v2
    v_ldexp_f32 v144, v144, v3
    v_ldexp_f32 v145, v145, v3
    v_ldexp_f32 v146, v146, v3
    v_ldexp_f32 v147, v147, v3
    v_ldexp_f32 v148, v148, v3
    v_ldexp_f32 v149, v149, v3
    v_ldexp_f32 v150, v150, v3
    v_ldexp_f32 v151, v151, v3
    v_ldexp_f32 v152, v152, v3
    v_ldexp_f32 v153, v153, v3
    v_ldexp_f32 v154, v154, v3
    v_frexp_exp_i32_f32 v2, v170
    v_add_u32 v2, 96, v2
    v_mov_b32 v3, v2
    s_nop 1
    v_permlane32_swap_b32 v2, v3
    s_nop 1
    v_sub_u32 v3, 0, v2
    v_cvt_f32_i32 v4, v2
    v_ldexp_f32 v160, v160, v3
    v_ldexp_f32 v161, v161, v3
    v_ldexp_f32 v162, v162, v3
    v_ldexp_f32 v163, v163, v3
    v_ldexp_f32 v164, v164, v3
    v_ldexp_f32 v165, v165, v3
    v_ldexp_f32 v166, v166, v3
    v_ldexp_f32 v167, v167, v3
    v_ldexp_f32 v168, v168, v3
    v_ldexp_f32 v169, v169, v3
    v_ldexp_f32 v170, v170, v3
    v_add_f32 v2, abs(v144), abs(v160)
    v_add_f32 v2, v2, abs(v145)
    v_add_f32 v2, v2, abs(v146)
    v_add_f32 v2, v2, abs(v147)
    v_add_f32 v2, v2, abs(v148)
    v_add_f32 v2, v2, abs(v149)
    v_add_f32 v2, v2, abs(v150)
    v_add_f32 v2, v2, abs(v151)
    v_add_f32 v2, v2, abs(v152)
    v_add_f32 v2, v2, abs(v153)
    v_add_f32 v2, v2, abs(v154)
    v_add_f32 v2, v2, abs(v161)
    v_add_f32 v2, v2, abs(v162)
    v_add_f32 v2, v2, abs(v163)
    v_add_f32 v2, v2, abs(v164)
    v_add_f32 v2, v2, abs(v165)
    v_add_f32 v2, v2, abs(v166)
    v_add_f32 v2, v2, abs(v167)
    v_add_f32 v2, v2, abs(v168)
    v_add_f32 v2, v2, abs(v169)
    v_add_f32 v2, v2, abs(v170)
    v_mov_b32 v3, 0x7f800000
    v_cmp_nlt_f32 vcc, v2, v3
    s_cmp_lg_u32 s50, 0
    s_cbranch_scc1 at_store
    s_cmp_lg_u64 vcc, 0
    s_cbranch_scc1 at_fallback
at_store:
    s_mul_i32 s44, s43, 36
    v_mov_b32 v2, v154
    v_mov_b32 v3, v154
    s_nop 1
    v_permlane32_swap_b32 v2, v3
    s_nop 1
    v_rcp_f32 v2, v2
    s_nop 0
    v_mul_f32 v144, v144, v2
    v_mul_f32 v145, v145, v2
    v_mul_f32 v146, v146, v2
    v_mul_f32 v147, v147, v2
    v_mul_f32 v148, v148, v2
    v_mul_f32 v149, v149, v2
    v_mul_f32 v150, v150, v2
    v_mul_f32 v151, v151, v2
    v_mul_f32 v152, v152, v2
    v_mul_f32 v153, v153, v2
    v_cvt_pk_bf16_f32 v60, v144, v145
    v_cvt_pk_bf16_f32 v61, v146, v147
    v_cvt_pk_bf16_f32 v62, v148, v149
    v_cvt_pk_bf16_f32 v63, v150, v151
    v_cvt_pk_bf16_f32 v64, v152, v153
    v_mov_b32 v2, v170
    v_mov_b32 v3, v170
    s_nop 1
    v_permlane32_swap_b32 v2, v3
    s_nop 1
    v_rcp_f32 v2, v2
    s_nop 0
    v_mul_f32 v160, v160, v2
    v_mul_f32 v161, v161, v2
    v_mul_f32 v162, v162, v2
    v_mul_f32 v163, v163, v2
    v_mul_f32 v164, v164, v2
    v_mul_f32 v165, v165, v2
    v_mul_f32 v166, v166, v2
    v_mul_f32 v167, v167, v2
    v_mul_f32 v168, v168, v2
    v_mul_f32 v169, v169, v2
    v_cvt_pk_bf16_f32 v68, v160, v161
    v_cvt_pk_bf16_f32 v69, v162, v163
    v_cvt_pk_bf16_f32 v70, v164, v165
    v_cvt_pk_bf16_f32 v71, v166, v167
    v_cvt_pk_bf16_f32 v65, v168, v169
    s_add_u32 s45, s44, s41
    s_lshl_b32 s45, s45, 10
    s_add_u32 s45, s45, 23068672
    buffer_store_dwordx4 v[60:63], v11, s[12:15], s45 offen sc1
    buffer_store_dwordx4 v[68:71], v11, s[12:15], s45 offen offset:1024 sc1
    s_lshr_b32 s45, s41, 3
    s_add_u32 s45, s45, s44
    s_add_u32 s45, s45, 32
    s_lshl_b32 s45, s45, 10
    s_add_u32 s45, s45, 23068672
    s_bfe_u32 s46, s41, 0x10001
    s_lshl_b32 s46, s46, 9
    s_add_u32 s45, s45, s46
    s_bfe_u32 s46, s41, 0x10002
    s_lshl_b32 s46, s46, 3
    s_add_u32 s45, s45, s46
    v_cmp_gt_u32 vcc, 32, v1
    s_and_saveexec_b64 s[64:65], vcc
    buffer_store_dwordx2 v[64:65], v11, s[12:15], s45 offen sc1
    s_waitcnt vmcnt(0) lgkmcnt(0)
    s_mov_b64 exec, 1
    ds_add_rtn_u32 v26, v18, v19 offset:28
    s_mov_b64 exec, -1
    s_waitcnt lgkmcnt(0)
    v_readfirstlane_b32 s60, v26
    s_cmp_lg_u32 s60, 7
    s_cbranch_scc1 at_nopub
    s_lshl_b32 s60, s42, 11
    s_add_u32 s60, s60, s62
    s_add_u32 s60, s60, 22610000
    v_lshlrev_b32 v3, 7, v1
    s_mov_b64 exec, 0xffff
    buffer_store_byte v19, v3, s[12:15], s60 offen sc1
at_nopub:
    s_endpgm
at_poll:
    s_sleep 1
    ds_read_b32 v26, v18
    s_waitcnt lgkmcnt(0)
    v_readfirstlane_b32 s55, v26
    s_cmp_lt_u32 s55, s54
    s_cbranch_scc1 at_poll
    s_branch at_poll_ret
at_rca:
    s_nop 7
    v_frexp_exp_i32_f32 v2, v154
    v_add_u32 v2, 96, v2
    v_mov_b32 v3, v2
    s_nop 1
    v_permlane32_swap_b32 v2, v3
    s_nop 1
    v_sub_u32 v3, 0, v2
    v_cvt_f32_i32 v4, v2
    v_ldexp_f32 v144, v144, v3
    v_ldexp_f32 v145, v145, v3
    v_ldexp_f32 v146, v146, v3
    v_ldexp_f32 v147, v147, v3
    v_ldexp_f32 v148, v148, v3
    v_ldexp_f32 v149, v149, v3
    v_ldexp_f32 v150, v150, v3
    v_ldexp_f32 v151, v151, v3
    v_ldexp_f32 v152, v152, v3
    v_ldexp_f32 v153, v153, v3
    v_ldexp_f32 v154, v154, v3
    v_sub_f32 v112, v112, v4
    v_sub_f32 v80, v80, v4
    v_sub_f32 v113, v113, v4
    v_sub_f32 v81, v81, v4
    v_sub_f32 v114, v114, v4
    v_sub_f32 v82, v82, v4
    v_sub_f32 v115, v115, v4
    v_sub_f32 v83, v83, v4
    v_sub_f32 v116, v116, v4
    v_sub_f32 v84, v84, v4
    v_sub_f32 v117, v117, v4
    v_sub_f32 v85, v85, v4
    v_sub_f32 v118, v118, v4
    v_sub_f32 v86, v86, v4
    v_sub_f32 v119, v119, v4
    v_sub_f32 v87, v87, v4
    v_sub_f32 v120, v120, v4
    v_sub_f32 v88, v88, v4
    v_sub_f32 v121, v121, v4
    v_sub_f32 v89, v89, v4
    v_sub_f32 v122, v122, v4
    v_sub_f32 v90, v90, v4
    v_sub_f32 v123, v123, v4
    v_sub_f32 v91, v91, v4
    v_sub_f32 v124, v124, v4
    v_sub_f32 v92, v92, v4
    v_sub_f32 v125, v125, v4
    v_sub_f32 v93, v93, v4
    v_sub_f32 v126, v126, v4
    v_sub_f32 v94, v94, v4
    v_sub_f32 v127, v127, v4
    v_sub_f32 v95, v95, v4
    s_nop 1
    s_branch at_rca_ret
at_rcb:
    s_nop 7
    v_frexp_exp_i32_f32 v2, v170
    v_add_u32 v2, 96, v2
    v_mov_b32 v3, v2
    s_nop 1
    v_permlane32_swap_b32 v2, v3
    s_nop 1
    v_sub_u32 v3, 0, v2
    v_cvt_f32_i32 v4, v2
    v_ldexp_f32 v160, v160, v3
    v_ldexp_f32 v161, v161, v3
    v_ldexp_f32 v162, v162, v3
    v_ldexp_f32 v163, v163, v3
    v_ldexp_f32 v164, v164, v3
    v_ldexp_f32 v165, v165, v3
    v_ldexp_f32 v166, v166, v3
    v_ldexp_f32 v167, v167, v3
    v_ldexp_f32 v168, v168, v3
    v_ldexp_f32 v169, v169, v3
    v_ldexp_f32 v170, v170, v3
    v_sub_f32 v128, v128, v4
    v_sub_f32 v96, v96, v4
    v_sub_f32 v129, v129, v4
    v_sub_f32 v97, v97, v4
    v_sub_f32 v130, v130, v4
    v_sub_f32 v98, v98, v4
    v_sub_f32 v131, v131, v4
    v_sub_f32 v99, v99, v4
    v_sub_f32 v132, v132, v4
    v_sub_f32 v100, v100, v4
    v_sub_f32 v133, v133, v4
    v_sub_f32 v101, v101, v4
    v_sub_f32 v134, v134, v4
    v_sub_f32 v102, v102, v4
    v_sub_f32 v135, v135, v4
    v_sub_f32 v103, v103, v4
    v_sub_f32 v136, v136, v4
    v_sub_f32 v104, v104, v4
    v_sub_f32 v137, v137, v4
    v_sub_f32 v105, v105, v4
    v_sub_f32 v138, v138, v4
    v_sub_f32 v106, v106, v4
    v_sub_f32 v139, v139, v4
    v_sub_f32 v107, v107, v4
    v_sub_f32 v140, v140, v4
    v_sub_f32 v108, v108, v4
    v_sub_f32 v141, v141, v4
    v_sub_f32 v109, v109, v4
    v_sub_f32 v142, v142, v4
    v_sub_f32 v110, v110, v4
    v_sub_f32 v143, v143, v4
    v_sub_f32 v111, v111, v4
    s_nop 1
    s_branch at_rcb_ret
at_fallback:
    s_mov_b32 s50, 1
    s_waitcnt vmcnt(0) lgkmcnt(0)
    v_and_b32 v2, 31, v1
    v_lshlrev_b32 v7, 2, v2
    v_add_u32 v7, 1024, v7
    v_min_u32 v3, 18, v2
    v_lshrrev_b32 v4, 5, v1
    v_mul_u32_u24 v4, 19, v4
    v_add_u32 v3, v3, v4
    v_lshlrev_b32 v3, 4, v3
    v_add_u32 v8, 1152, v3
    v_mov_b32 v2, 0xff800000
    v_mov_b32 v4, 0xff800000
    s_mov_b32 s51, 0
    s_mov_b32 s46, 22020096
at_fb1:
    buffer_load_dwordx4 v[28:31], v11, s[12:15], s46 offen sc1
    buffer_load_dword v32, v7, s[12:15], s46 offen sc1
    s_waitcnt vmcnt(0)
    v_mfma_f32_32x32x16_bf16 v[80:95], v[28:31], v[12:15], 0
    v_mfma_f32_32x32x8_bf16 v[80:95], v[32:33], v[16:17], v[80:95]
    v_mfma_f32_32x32x16_bf16 v[96:111], v[28:31], v[20:23], 0
    v_mfma_f32_32x32x8_bf16 v[96:111], v[32:33], v[24:25], v[96:111]
    s_add_u32 s46, s46, 2368
    s_nop 7
    s_nop 3
    v_max3_f32 v3, v80, v81, v82
    v_max3_f32 v3, v3, v83, v84
    v_max3_f32 v3, v3, v85, v86
    v_max3_f32 v3, v3, v87, v88
    v_max3_f32 v3, v3, v89, v90
    v_max3_f32 v3, v3, v91, v92
    v_max3_f32 v3, v3, v93, v94
    v_max_f32 v3, v3, v95
    v_max_f32 v2, v2, v3
    v_max3_f32 v3, v96, v97, v98
    v_max3_f32 v3, v3, v99, v100
    v_max3_f32 v3, v3, v101, v102
    v_max3_f32 v3, v3, v103, v104
    v_max3_f32 v3, v3, v105, v106
    v_max3_f32 v3, v3, v107, v108
    v_max3_f32 v3, v3, v109, v110
    v_max_f32 v3, v3, v111
    v_max_f32 v4, v4, v3
    s_add_u32 s51, s51, 1
    s_cmp_lt_u32 s51, 64
    s_cbranch_scc1 at_fb1
    v_mov_b32 v3, v2
    s_nop 1
    v_permlane32_swap_b32 v2, v3
    s_nop 1
    v_max_f32 v2, v2, v3
    v_mov_b32 v5, v4
    s_nop 1
    v_permlane32_swap_b32 v4, v5
    s_nop 1
    v_max_f32 v4, v4, v5
    v_add_f32 v2, 1119879168, v2
    v_sub_f32 v2, 0, v2
    v_mov_b32 v112, v2
    v_mov_b32 v113, v2
    v_mov_b32 v114, v2
    v_mov_b32 v115, v2
    v_mov_b32 v116, v2
    v_mov_b32 v117, v2
    v_mov_b32 v118, v2
    v_mov_b32 v119, v2
    v_mov_b32 v120, v2
    v_mov_b32 v121, v2
    v_mov_b32 v122, v2
    v_mov_b32 v123, v2
    v_mov_b32 v124, v2
    v_mov_b32 v125, v2
    v_mov_b32 v126, v2
    v_mov_b32 v127, v2
    v_add_f32 v4, 1119879168, v4
    v_sub_f32 v4, 0, v4
    v_mov_b32 v128, v4
    v_mov_b32 v129, v4
    v_mov_b32 v130, v4
    v_mov_b32 v131, v4
    v_mov_b32 v132, v4
    v_mov_b32 v133, v4
    v_mov_b32 v134, v4
    v_mov_b32 v135, v4
    v_mov_b32 v136, v4
    v_mov_b32 v137, v4
    v_mov_b32 v138, v4
    v_mov_b32 v139, v4
    v_mov_b32 v140, v4
    v_mov_b32 v141, v4
    v_mov_b32 v142, v4
    v_mov_b32 v143, v4
    v_mov_b32 v144, 0
    v_mov_b32 v145, 0
    v_mov_b32 v146, 0
    v_mov_b32 v147, 0
    v_mov_b32 v148, 0
    v_mov_b32 v149, 0
    v_mov_b32 v150, 0
    v_mov_b32 v151, 0
    v_mov_b32 v152, 0
    v_mov_b32 v153, 0
    v_mov_b32 v154, 0
    v_mov_b32 v155, 0
    v_mov_b32 v156, 0
    v_mov_b32 v157, 0
    v_mov_b32 v158, 0
    v_mov_b32 v159, 0
    v_mov_b32 v160, 0
    v_mov_b32 v161, 0
    v_mov_b32 v162, 0
    v_mov_b32 v163, 0
    v_mov_b32 v164, 0
    v_mov_b32 v165, 0
    v_mov_b32 v166, 0
    v_mov_b32 v167, 0
    v_mov_b32 v168, 0
    v_mov_b32 v169, 0
    v_mov_b32 v170, 0
    v_mov_b32 v171, 0
    v_mov_b32 v172, 0
    v_mov_b32 v173, 0
    v_mov_b32 v174, 0
    v_mov_b32 v175, 0
    s_mov_b32 s51, 0
    s_mov_b32 s46, 22020096
at_fb2:
    buffer_load_dwordx4 v[28:31], v11, s[12:15], s46 offen sc1
    buffer_load_dword v32, v7, s[12:15], s46 offen sc1
    buffer_load_dwordx4 v[44:47], v8, s[12:15], s46 offen sc1
    buffer_load_dwordx4 v[48:51], v8, s[12:15], s46 offen offset:608 sc1
    s_waitcnt vmcnt(0)
    v_mfma_f32_32x32x16_bf16 v[80:95], v[28:31], v[12:15], v[112:127]
    v_mfma_f32_32x32x8_bf16 v[80:95], v[32:33], v[16:17], v[80:95]
    v_mfma_f32_32x32x16_bf16 v[96:111], v[28:31], v[20:23], v[128:143]
    v_mfma_f32_32x32x8_bf16 v[96:111], v[32:33], v[24:25], v[96:111]
    s_add_u32 s46, s46, 2368
    s_nop 7
    s_nop 3
    v_exp_f32 v80, v80
    v_exp_f32 v81, v81
    v_exp_f32 v82, v82
    v_exp_f32 v83, v83
    v_exp_f32 v84, v84
    v_exp_f32 v85, v85
    v_exp_f32 v86, v86
    v_exp_f32 v87, v87
    v_exp_f32 v88, v88
    v_exp_f32 v89, v89
    v_exp_f32 v90, v90
    v_exp_f32 v91, v91
    v_exp_f32 v92, v92
    v_exp_f32 v93, v93
    v_exp_f32 v94, v94
    v_exp_f32 v95, v95
    s_nop 0
    v_cvt_pk_bf16_f32 v60, v80, v81
    v_cvt_pk_bf16_f32 v61, v82, v83
    v_cvt_pk_bf16_f32 v62, v84, v85
    v_cvt_pk_bf16_f32 v63, v86, v87
    v_cvt_pk_bf16_f32 v64, v88, v89
    v_cvt_pk_bf16_f32 v65, v90, v91
    v_cvt_pk_bf16_f32 v66, v92, v93
    v_cvt_pk_bf16_f32 v67, v94, v95
    v_exp_f32 v96, v96
    v_exp_f32 v97, v97
    v_exp_f32 v98, v98
    v_exp_f32 v99, v99
    v_exp_f32 v100, v100
    v_exp_f32 v101, v101
    v_exp_f32 v102, v102
    v_exp_f32 v103, v103
    v_exp_f32 v104, v104
    v_exp_f32 v105, v105
    v_exp_f32 v106, v106
    v_exp_f32 v107, v107
    v_exp_f32 v108, v108
    v_exp_f32 v109, v109
    v_exp_f32 v110, v110
    v_exp_f32 v111, v111
    s_nop 0
    v_cvt_pk_bf16_f32 v68, v96, v97
    v_cvt_pk_bf16_f32 v69, v98, v99
    v_cvt_pk_bf16_f32 v70, v100, v101
    v_cvt_pk_bf16_f32 v71, v102, v103
    v_cvt_pk_bf16_f32 v72, v104, v105
    v_cvt_pk_bf16_f32 v73, v106, v107
    v_cvt_pk_bf16_f32 v74, v108, v109
    v_cvt_pk_bf16_f32 v75, v110, v111
    s_nop 1
    v_mfma_f32_32x32x16_bf16 v[144:159], v[44:47], v[60:63], v[144:159]
    v_mfma_f32_32x32x16_bf16 v[144:159], v[48:51], v[64:67], v[144:159]
    v_mfma_f32_32x32x16_bf16 v[160:175], v[44:47], v[68:71], v[160:175]
    v_mfma_f32_32x32x16_bf16 v[160:175], v[48:51], v[72:75], v[160:175]
    s_add_u32 s51, s51, 1
    s_cmp_lt_u32 s51, 64
    s_nop 7
    s_cbranch_scc1 at_fb2
    s_branch at_finish
ka_end:
    s_endpgm
all_code_end:
    s_endpgm
.section .rodata,"a"
.p2align 6
.amdhsa_kernel parallel_sum__grouped_kv_mqa__dense_activation_squared_relu__prompt_kernel
  .amdhsa_next_free_vgpr 256
  .amdhsa_next_free_sgpr 102
  .amdhsa_accum_offset 256
  .amdhsa_group_segment_fixed_size 0
  .amdhsa_kernarg_size 104
  .amdhsa_user_sgpr_count 2
  .amdhsa_user_sgpr_kernarg_segment_ptr 1
  .amdhsa_system_sgpr_workgroup_id_x 1
.end_amdhsa_kernel
```
